```python
import torch

def _softmax(x, axis=-1):
    return torch.softmax(x, dim=axis)
def _gelu(x):
    return torch.nn.functional.gelu(x, approximate="tanh")
def _silu(x):
    return torch.nn.functional.silu(x)
def _sigmoid(x):
    return torch.sigmoid(x)
def _layernorm(x, axis=-1, eps=1e-5):
    m = x.mean(dim=axis, keepdim=True)
    v = x.var(dim=axis, keepdim=True, unbiased=False)
    return (x - m) / torch.sqrt(v + eps)
def _scatter_add(tgt, idx, src, axis=0):
    return tgt.clone().index_add_(axis, idx, src)
def _segment_sum(src, seg, n):
    out = torch.zeros((n,) + src.shape[1:], dtype=src.dtype)
    return out.index_add_(0, seg, src)
def _pad(x, pw):
    flat = tuple(v for pair in reversed(pw) for v in pair)
    return torch.nn.functional.pad(x, flat)

kernel_name = 'standalone__dcn_v2_cross__recsys'

def setup_inputs():

    _w = (lambda a: (lambda t: t.to(torch.bfloat16) if t.is_floating_point() else t)(torch.as_tensor(a)))
    B, F, D, L = 4096, 26, 128, 6
    Din = min(F * D, 1024)
    return {
        "x0": _w((lambda *s: torch.randn(*s, dtype=torch.bfloat16) * 0.05)(B, Din)),
        "ws": _w((lambda *s: torch.randn(*s, dtype=torch.bfloat16) * 0.05)(L, Din, Din)),
        "bs": _w((lambda *s: torch.randn(*s, dtype=torch.bfloat16) * 0.05)(L, Din)),
    }

def reference(x0, ws, bs):
    x = x0
    for l in range(ws.shape[0]):
        x = x0 * (x @ ws[l] + bs[l]) + x
    return x
```

```asm
; @launch grid=(256,1,1) block=(512,1,1) lds=163840
.amdgcn_target "amdgcn-amd-amdhsa--gfx950"
.text
.globl standalone__dcn_v2_cross__recsys_kernel
.p2align 8
.type standalone__dcn_v2_cross__recsys_kernel,@function
standalone__dcn_v2_cross__recsys_kernel:
  s_cmp_ge_u32 s2, 256
  s_cbranch_scc1 L_end
  s_load_dwordx4 s[4:7], s[0:1], 0
  s_load_dwordx4 s[8:11], s[0:1], 16
  s_load_dwordx4 s[12:15], s[0:1], 32
  v_lshrrev_b32 v1, 6, v0
  v_and_b32 v0, 63, v0
  s_and_b32 s44, s2, 7
  v_readfirstlane_b32 s40, v1
  s_lshr_b32 s45, s2, 3
  s_lshr_b32 s43, s45, 3
  s_and_b32 s42, s45, 7
  s_lshl_b32 s44, s44, 2
  s_add_u32 s41, s44, s43
  s_waitcnt lgkmcnt(0)
  s_mov_b32 s16, s4
  s_mov_b32 s17, s5
  s_mov_b32 s18, 0x800000
  s_mov_b32 s19, 0x20000
  s_mov_b32 s20, s6
  s_mov_b32 s21, s7
  s_mov_b32 s22, 0xc00000
  s_mov_b32 s23, 0x20000
  s_mov_b32 s24, s8
  s_mov_b32 s25, s9
  s_mov_b32 s26, 0x3000
  s_mov_b32 s27, 0x20000
  s_mov_b32 s28, s10
  s_mov_b32 s29, s11
  s_mov_b32 s30, 0x800000
  s_mov_b32 s31, 0x20000
  s_mov_b32 s32, s12
  s_mov_b32 s33, s13
  s_mov_b32 s34, 0x100
  s_mov_b32 s35, 0x20000
  s_mov_b32 s36, s14
  s_mov_b32 s37, s15
  s_mov_b32 s38, 0x3800000
  s_mov_b32 s39, 0x20000
  s_cmp_ge_u32 s40, 6
  s_cbranch_scc1 L_wload
  s_cmp_ge_u32 s40, 4
  s_cbranch_scc1 L_xload

  s_lshr_b32 s44, s40, 1
  s_and_b32 s45, s40, 1
  v_and_b32 v160, 15, v0
  v_lshrrev_b32 v161, 4, v0
  v_lshlrev_b32 v251, 11, v160
  v_lshl_add_u32 v251, v161, 3, v251
  s_lshl_b32 s52, s41, 1
  s_add_u32 s52, s52, s44
  s_lshl_b32 s55, s52, 17
  s_lshl_b32 s52, s42, 1
  s_add_u32 s52, s52, s45
  s_lshl_b32 s54, s52, 7
  s_add_u32 s55, s55, s54
  v_lshlrev_b32 v252, 3, v161
  buffer_load_dwordx2 v[232:233], v252, s[24:27], s54 offen offset:0
  buffer_load_dwordx2 v[234:235], v252, s[24:27], s54 offen offset:32
  buffer_load_dwordx2 v[236:237], v252, s[24:27], s54 offen offset:64
  buffer_load_dwordx2 v[238:239], v252, s[24:27], s54 offen offset:96
  s_lshl_b32 s52, s42, 2
  s_add_u32 s52, s52, s40
  s_lshl_b32 s52, s52, 2
  s_lshl_b32 s53, s41, 8
  s_add_u32 s52, s52, s53
  v_mov_b32 v253, 0x40000000
  v_mov_b32 v162, s52
  v_cmp_eq_u32 vcc, 0, v0
  s_nop 1
  v_cndmask_b32 v253, v253, v162, vcc
  s_cmp_lg_u32 s40, 0
  s_cbranch_scc1 L_c_noreset
  v_lshl_add_u32 v162, v0, 2, s52
  s_lshl_b32 s52, s42, 3
  s_add_u32 s52, s52, s53
  s_add_u32 s52, s52, 112
  v_lshl_add_u32 v163, v0, 2, s52
  v_cmp_gt_u32 vcc, 4, v0
  s_nop 1
  v_cndmask_b32 v162, v163, v162, vcc
  v_mov_b32 v163, 0x40000000
  v_cmp_gt_u32 vcc, 6, v0
  s_nop 1
  v_cndmask_b32 v162, v163, v162, vcc
  v_mov_b32 v163, 0
  buffer_store_dword v163, v162, s[36:39], 0 offen sc1
L_c_noreset:
  v_lshrrev_b32 v162, 2, v160
  v_and_b32 v163, 1, v161
  v_lshl_add_u32 v163, v163, 2, v162
  v_lshl_add_u32 v162, v161, 3, v162
  v_lshlrev_b32 v162, 8, v162
  v_and_b32 v164, 3, v0
  v_lshl_add_u32 v162, v164, 3, v162
  v_add_u32 v162, 0x10000, v162
  s_lshl_b32 s52, s45, 2
  s_add_u32 s53, s52, 0
  v_xor_b32 v164, s53, v163
  v_lshl_add_u32 v240, v164, 5, v162
  v_add_u32 v244, 1024, v240
  s_add_u32 s53, s52, 1
  v_xor_b32 v164, s53, v163
  v_lshl_add_u32 v241, v164, 5, v162
  v_add_u32 v245, 1024, v241
  s_add_u32 s53, s52, 2
  v_xor_b32 v164, s53, v163
  v_lshl_add_u32 v242, v164, 5, v162
  v_add_u32 v246, 1024, v242
  s_add_u32 s53, s52, 3
  v_xor_b32 v164, s53, v163
  v_lshl_add_u32 v243, v164, 5, v162
  v_add_u32 v247, 1024, v243
  v_lshrrev_b32 v162, 1, v160
  v_xor_b32 v162, v162, v161
  v_lshlrev_b32 v162, 4, v162
  v_lshl_add_u32 v162, v160, 7, v162
  s_lshl_b32 s52, s44, 13
  v_add_u32 v248, s52, v162
  v_xor_b32 v249, 64, v248
  v_lshlrev_b32 v250, 4, v0
  v_add_u32 v250, s52, v250
  s_lshl_b32 s52, s45, 14
  v_add_u32 v250, s52, v250
  s_lshl_b32 s51, s41, 18
  s_lshl_b32 s52, s42, 15
  s_add_u32 s51, s51, s52
  s_add_u32 s51, s51, 0x800000
  s_mov_b32 s46, 0
  s_mov_b32 s56, 0x8000
  s_mov_b32 s57, 0xffff0000
  s_mov_b32 s48, 0
  s_mov_b32 s50, 0
  s_barrier
  s_waitcnt vmcnt(0)
  s_cmp_lg_u32 s40, 0
  s_cbranch_scc1 L_c_noreg
  s_getreg_b32 s52, hwreg(HW_REG_XCC_ID, 0, 4)
  s_and_b32 s52, s52, 7
  s_or_b32 s52, s52, 8
  s_lshl_b32 s53, s42, 2
  s_lshl_b32 s52, s52, s53
  v_mov_b32 v162, s52
  s_lshl_b32 s53, s41, 2
  s_add_u32 s53, s53, 128
  v_and_b32 v163, 0x40000000, v253
  v_add_u32 v163, s53, v163
  buffer_atomic_add v162, v163, s[32:35], 0 offen
L_c_noreg:
  v_lshlrev_b32 v224, 16, v232
  v_and_b32 v225, 0xffff0000, v232
  v_lshlrev_b32 v226, 16, v233
  v_and_b32 v227, 0xffff0000, v233
  v_lshlrev_b32 v228, 16, v234
  v_and_b32 v229, 0xffff0000, v234
  v_lshlrev_b32 v230, 16, v235
  v_and_b32 v231, 0xffff0000, v235
  v_lshlrev_b32 v232, 16, v236
  v_and_b32 v233, 0xffff0000, v236
  v_lshlrev_b32 v234, 16, v237
  v_and_b32 v235, 0xffff0000, v237
  v_lshlrev_b32 v236, 16, v238
  v_and_b32 v237, 0xffff0000, v238
  v_lshlrev_b32 v238, 16, v239
  v_and_b32 v239, 0xffff0000, v239
L_layer:
  s_waitcnt lgkmcnt(0)
  s_barrier
  ds_read_b64_tr_b16 v[160:161], v240 offset:0
  ds_read_b64_tr_b16 v[162:163], v244 offset:0
  ds_read_b128 v[192:195], v248 offset:0
  ds_read_b128 v[196:199], v248 offset:2048
  ds_read_b64_tr_b16 v[164:165], v241 offset:0
  ds_read_b64_tr_b16 v[166:167], v245 offset:0
  ds_read_b64_tr_b16 v[168:169], v242 offset:0
  ds_read_b64_tr_b16 v[170:171], v246 offset:0
  ds_read_b64_tr_b16 v[172:173], v243 offset:0
  ds_read_b64_tr_b16 v[174:175], v247 offset:0
  ds_read_b128 v[200:203], v248 offset:4096
  ds_read_b128 v[204:207], v248 offset:6144
  s_waitcnt lgkmcnt(9)
  v_mfma_f32_16x16x32_bf16 v[0:3], v[160:163], v[192:195], v[224:227]
  s_waitcnt lgkmcnt(8)
  v_mfma_f32_16x16x32_bf16 v[16:19], v[160:163], v[196:199], v[224:227]
  ds_read_b64_tr_b16 v[176:177], v240 offset:8192
  s_waitcnt lgkmcnt(7)
  v_mfma_f32_16x16x32_bf16 v[20:23], v[164:167], v[196:199], v[228:231]
  ds_read_b64_tr_b16 v[178:179], v244 offset:8192
  v_mfma_f32_16x16x32_bf16 v[4:7], v[164:167], v[192:195], v[228:231]
  ds_read_b128 v[208:211], v249 offset:0
  s_waitcnt lgkmcnt(7)
  v_mfma_f32_16x16x32_bf16 v[8:11], v[168:171], v[192:195], v[232:235]
  ds_read_b128 v[212:215], v249 offset:2048
  v_mfma_f32_16x16x32_bf16 v[24:27], v[168:171], v[196:199], v[232:235]
  ds_read_b64_tr_b16 v[180:181], v241 offset:8192
  s_waitcnt lgkmcnt(7)
  v_mfma_f32_16x16x32_bf16 v[28:31], v[172:175], v[196:199], v[236:239]
  ds_read_b64_tr_b16 v[182:183], v245 offset:8192
  v_mfma_f32_16x16x32_bf16 v[12:15], v[172:175], v[192:195], v[236:239]
  ds_read_b64_tr_b16 v[184:185], v242 offset:8192
  s_waitcnt lgkmcnt(8)
  v_mfma_f32_16x16x32_bf16 v[40:43], v[168:171], v[200:203], v[232:235]
  s_cmp_eq_u32 s46, 0
  s_cbranch_scc1 L_flag_done
  s_lshl_b32 s52, s46, 1
  v_mov_b32 v254, s52
  s_waitcnt vmcnt(0)
  s_cmp_eq_u32 s50, 0
  s_cbranch_scc1 L_flag_slow
  buffer_store_dword v254, v253, s[36:39], 0 offen
L_flag_done:
  ds_read_b64_tr_b16 v[186:187], v246 offset:8192
  s_waitcnt lgkmcnt(8)
  v_mfma_f32_16x16x32_bf16 v[56:59], v[168:171], v[204:207], v[232:235]
  ds_read_b64_tr_b16 v[188:189], v243 offset:8192
  v_mfma_f32_16x16x32_bf16 v[60:63], v[172:175], v[204:207], v[236:239]
  ds_read_b64_tr_b16 v[190:191], v247 offset:8192
  v_mfma_f32_16x16x32_bf16 v[44:47], v[172:175], v[200:203], v[236:239]
  ds_read_b128 v[216:219], v249 offset:4096
  v_mfma_f32_16x16x32_bf16 v[32:35], v[160:163], v[200:203], v[224:227]
  ds_read_b128 v[220:223], v249 offset:6144
  v_mfma_f32_16x16x32_bf16 v[48:51], v[160:163], v[204:207], v[224:227]
  v_mfma_f32_16x16x32_bf16 v[52:55], v[164:167], v[204:207], v[228:231]
  v_mfma_f32_16x16x32_bf16 v[36:39], v[164:167], v[200:203], v[228:231]
  s_add_u32 s54, s54, 2048
  s_cmp_eq_u32 s46, 0
  s_cbranch_scc1 L_first_b1
L_first_b1_done:
  s_waitcnt lgkmcnt(9)
  v_mfma_f32_16x16x32_bf16 v[0:3], v[176:179], v[208:211], v[0:3]
  s_waitcnt lgkmcnt(8)
  v_mfma_f32_16x16x32_bf16 v[16:19], v[176:179], v[212:215], v[16:19]
  ds_read_b64_tr_b16 v[160:161], v240 offset:16384
  s_waitcnt lgkmcnt(7)
  v_mfma_f32_16x16x32_bf16 v[20:23], v[180:183], v[212:215], v[20:23]
  ds_read_b64_tr_b16 v[162:163], v244 offset:16384
  v_mfma_f32_16x16x32_bf16 v[4:7], v[180:183], v[208:211], v[4:7]
  ds_read_b128 v[192:195], v248 offset:16384
  s_waitcnt lgkmcnt(7)
  v_mfma_f32_16x16x32_bf16 v[8:11], v[184:187], v[208:211], v[8:11]
  ds_read_b128 v[196:199], v248 offset:18432
  v_mfma_f32_16x16x32_bf16 v[24:27], v[184:187], v[212:215], v[24:27]
  s_add_u32 s48, s48, 1
  ds_read_b64_tr_b16 v[164:165], v241 offset:16384
  s_waitcnt lgkmcnt(7)
  v_mfma_f32_16x16x32_bf16 v[28:31], v[188:191], v[212:215], v[28:31]
  s_cmp_eq_u32 s48, 3
  ds_read_b64_tr_b16 v[166:167], v245 offset:16384
  v_mfma_f32_16x16x32_bf16 v[12:15], v[188:191], v[208:211], v[12:15]
  s_cselect_b32 s49, s57, s56
  ds_read_b64_tr_b16 v[168:169], v242 offset:16384
  s_waitcnt lgkmcnt(8)
  v_mfma_f32_16x16x32_bf16 v[40:43], v[184:187], v[216:219], v[40:43]
  ds_read_b64_tr_b16 v[170:171], v246 offset:16384
  s_waitcnt lgkmcnt(8)
  v_mfma_f32_16x16x32_bf16 v[56:59], v[184:187], v[220:223], v[56:59]
  s_cselect_b32 s48, 0, s48
  ds_read_b64_tr_b16 v[172:173], v243 offset:16384
  v_mfma_f32_16x16x32_bf16 v[60:63], v[188:191], v[220:223], v[60:63]
  ds_read_b64_tr_b16 v[174:175], v247 offset:16384
  v_mfma_f32_16x16x32_bf16 v[44:47], v[188:191], v[216:219], v[44:47]
  ds_read_b128 v[200:203], v248 offset:20480
  v_mfma_f32_16x16x32_bf16 v[32:35], v[176:179], v[216:219], v[32:35]
  ds_read_b128 v[204:207], v248 offset:22528
  v_mfma_f32_16x16x32_bf16 v[48:51], v[176:179], v[220:223], v[48:51]
  v_mfma_f32_16x16x32_bf16 v[52:55], v[180:183], v[220:223], v[52:55]
  v_mfma_f32_16x16x32_bf16 v[36:39], v[180:183], v[216:219], v[36:39]
  s_cmp_eq_u32 s46, 0
  s_cbranch_scc1 L_first_b2
L_first_b2_done:
  s_waitcnt lgkmcnt(9)
  v_mfma_f32_16x16x32_bf16 v[0:3], v[160:163], v[192:195], v[0:3]
  s_waitcnt lgkmcnt(8)
  v_mfma_f32_16x16x32_bf16 v[16:19], v[160:163], v[196:199], v[16:19]
  ds_read_b64_tr_b16 v[176:177], v240 offset:24576
  s_waitcnt lgkmcnt(7)
  v_mfma_f32_16x16x32_bf16 v[20:23], v[164:167], v[196:199], v[20:23]
  ds_read_b64_tr_b16 v[178:179], v244 offset:24576
  v_mfma_f32_16x16x32_bf16 v[4:7], v[164:167], v[192:195], v[4:7]
  ds_read_b128 v[208:211], v249 offset:16384
  s_waitcnt lgkmcnt(7)
  v_mfma_f32_16x16x32_bf16 v[8:11], v[168:171], v[192:195], v[8:11]
  ds_read_b128 v[212:215], v249 offset:18432
  v_mfma_f32_16x16x32_bf16 v[24:27], v[168:171], v[196:199], v[24:27]
  v_xor_b32 v248, 0x8000, v248
  ds_read_b64_tr_b16 v[180:181], v241 offset:24576
  s_waitcnt lgkmcnt(7)
  v_mfma_f32_16x16x32_bf16 v[28:31], v[172:175], v[196:199], v[28:31]
  ds_read_b64_tr_b16 v[182:183], v245 offset:24576
  v_mfma_f32_16x16x32_bf16 v[12:15], v[172:175], v[192:195], v[12:15]
  ds_read_b64_tr_b16 v[184:185], v242 offset:24576
  s_waitcnt lgkmcnt(8)
  v_mfma_f32_16x16x32_bf16 v[40:43], v[168:171], v[200:203], v[40:43]
  ds_read_b64_tr_b16 v[186:187], v246 offset:24576
  s_waitcnt lgkmcnt(8)
  v_mfma_f32_16x16x32_bf16 v[56:59], v[168:171], v[204:207], v[56:59]
  ds_read_b64_tr_b16 v[188:189], v243 offset:24576
  v_mfma_f32_16x16x32_bf16 v[60:63], v[172:175], v[204:207], v[60:63]
  v_add_u32 v240, s49, v240
  ds_read_b64_tr_b16 v[190:191], v247 offset:24576
  v_mfma_f32_16x16x32_bf16 v[44:47], v[172:175], v[200:203], v[44:47]
  v_add_u32 v244, s49, v244
  ds_read_b128 v[216:219], v249 offset:20480
  v_mfma_f32_16x16x32_bf16 v[32:35], v[160:163], v[200:203], v[32:35]
  v_add_u32 v241, s49, v241
  ds_read_b128 v[220:223], v249 offset:22528
  v_mfma_f32_16x16x32_bf16 v[48:51], v[160:163], v[204:207], v[48:51]
  v_add_u32 v245, s49, v245
  v_add_u32 v242, s49, v242
  v_mfma_f32_16x16x32_bf16 v[52:55], v[164:167], v[204:207], v[52:55]
  v_add_u32 v246, s49, v246
  v_add_u32 v243, s49, v243
  v_mfma_f32_16x16x32_bf16 v[36:39], v[164:167], v[200:203], v[36:39]
  v_add_u32 v247, s49, v247
  s_cmp_eq_u32 s46, 0
  s_cbranch_scc1 L_first_own
L_first_own_done:
  s_barrier
  s_waitcnt lgkmcnt(9)
  v_mfma_f32_16x16x32_bf16 v[0:3], v[176:179], v[208:211], v[0:3]
  s_waitcnt lgkmcnt(8)
  v_mfma_f32_16x16x32_bf16 v[16:19], v[176:179], v[212:215], v[16:19]
  ds_read_b64_tr_b16 v[160:161], v240 offset:0
  s_waitcnt lgkmcnt(7)
  v_mfma_f32_16x16x32_bf16 v[20:23], v[180:183], v[212:215], v[20:23]
  ds_read_b64_tr_b16 v[162:163], v244 offset:0
  v_mfma_f32_16x16x32_bf16 v[4:7], v[180:183], v[208:211], v[4:7]
  ds_read_b128 v[192:195], v248 offset:0
  s_waitcnt lgkmcnt(7)
  v_mfma_f32_16x16x32_bf16 v[8:11], v[184:187], v[208:211], v[8:11]
  ds_read_b128 v[196:199], v248 offset:2048
  v_mfma_f32_16x16x32_bf16 v[24:27], v[184:187], v[212:215], v[24:27]
  ds_read_b64_tr_b16 v[164:165], v241 offset:0
  s_waitcnt lgkmcnt(7)
  v_mfma_f32_16x16x32_bf16 v[28:31], v[188:191], v[212:215], v[28:31]
  ds_read_b64_tr_b16 v[166:167], v245 offset:0
  v_mfma_f32_16x16x32_bf16 v[12:15], v[188:191], v[208:211], v[12:15]
  ds_read_b64_tr_b16 v[168:169], v242 offset:0
  s_waitcnt lgkmcnt(8)
  v_mfma_f32_16x16x32_bf16 v[40:43], v[184:187], v[216:219], v[40:43]
  ds_read_b64_tr_b16 v[170:171], v246 offset:0
  s_waitcnt lgkmcnt(8)
  v_mfma_f32_16x16x32_bf16 v[56:59], v[184:187], v[220:223], v[56:59]
  ds_read_b64_tr_b16 v[172:173], v243 offset:0
  v_mfma_f32_16x16x32_bf16 v[60:63], v[188:191], v[220:223], v[60:63]
  ds_read_b64_tr_b16 v[174:175], v247 offset:0
  v_mfma_f32_16x16x32_bf16 v[44:47], v[188:191], v[216:219], v[44:47]
  ds_read_b128 v[200:203], v248 offset:4096
  v_mfma_f32_16x16x32_bf16 v[32:35], v[176:179], v[216:219], v[32:35]
  ds_read_b128 v[204:207], v248 offset:6144
  v_mfma_f32_16x16x32_bf16 v[48:51], v[176:179], v[220:223], v[48:51]
  v_xor_b32 v249, 0x8000, v249
  v_mfma_f32_16x16x32_bf16 v[52:55], v[180:183], v[220:223], v[52:55]
  v_mfma_f32_16x16x32_bf16 v[36:39], v[180:183], v[216:219], v[36:39]
  s_mov_b32 s47, 7
L_body:
  s_barrier
  s_waitcnt lgkmcnt(9)
  v_mfma_f32_16x16x32_bf16 v[0:3], v[160:163], v[192:195], v[0:3]
  s_waitcnt lgkmcnt(8)
  v_mfma_f32_16x16x32_bf16 v[16:19], v[160:163], v[196:199], v[16:19]
  ds_read_b64_tr_b16 v[176:177], v240 offset:8192
  s_waitcnt lgkmcnt(7)
  v_mfma_f32_16x16x32_bf16 v[20:23], v[164:167], v[196:199], v[20:23]
  ds_read_b64_tr_b16 v[178:179], v244 offset:8192
  v_mfma_f32_16x16x32_bf16 v[4:7], v[164:167], v[192:195], v[4:7]
  ds_read_b128 v[208:211], v249 offset:0
  s_waitcnt lgkmcnt(7)
  v_mfma_f32_16x16x32_bf16 v[8:11], v[168:171], v[192:195], v[8:11]
  ds_read_b128 v[212:215], v249 offset:2048
  v_mfma_f32_16x16x32_bf16 v[24:27], v[168:171], v[196:199], v[24:27]
  ds_read_b64_tr_b16 v[180:181], v241 offset:8192
  s_waitcnt lgkmcnt(7)
  v_mfma_f32_16x16x32_bf16 v[28:31], v[172:175], v[196:199], v[28:31]
  ds_read_b64_tr_b16 v[182:183], v245 offset:8192
  v_mfma_f32_16x16x32_bf16 v[12:15], v[172:175], v[192:195], v[12:15]
  ds_read_b64_tr_b16 v[184:185], v242 offset:8192
  s_waitcnt lgkmcnt(8)
  v_mfma_f32_16x16x32_bf16 v[40:43], v[168:171], v[200:203], v[40:43]
  ds_read_b64_tr_b16 v[186:187], v246 offset:8192
  s_waitcnt lgkmcnt(8)
  v_mfma_f32_16x16x32_bf16 v[56:59], v[168:171], v[204:207], v[56:59]
  ds_read_b64_tr_b16 v[188:189], v243 offset:8192
  v_mfma_f32_16x16x32_bf16 v[60:63], v[172:175], v[204:207], v[60:63]
  ds_read_b64_tr_b16 v[190:191], v247 offset:8192
  v_mfma_f32_16x16x32_bf16 v[44:47], v[172:175], v[200:203], v[44:47]
  ds_read_b128 v[216:219], v249 offset:4096
  v_mfma_f32_16x16x32_bf16 v[32:35], v[160:163], v[200:203], v[32:35]
  ds_read_b128 v[220:223], v249 offset:6144
  v_mfma_f32_16x16x32_bf16 v[48:51], v[160:163], v[204:207], v[48:51]
  v_mfma_f32_16x16x32_bf16 v[52:55], v[164:167], v[204:207], v[52:55]
  v_mfma_f32_16x16x32_bf16 v[36:39], v[164:167], v[200:203], v[36:39]
  s_cmp_eq_u32 s47, 7
  s_cbranch_scc1 L_b5
L_b5_done:
  s_waitcnt lgkmcnt(9)
  v_mfma_f32_16x16x32_bf16 v[0:3], v[176:179], v[208:211], v[0:3]
  s_waitcnt lgkmcnt(8)
  v_mfma_f32_16x16x32_bf16 v[16:19], v[176:179], v[212:215], v[16:19]
  ds_read_b64_tr_b16 v[160:161], v240 offset:16384
  s_waitcnt lgkmcnt(7)
  v_mfma_f32_16x16x32_bf16 v[20:23], v[180:183], v[212:215], v[20:23]
  ds_read_b64_tr_b16 v[162:163], v244 offset:16384
  v_mfma_f32_16x16x32_bf16 v[4:7], v[180:183], v[208:211], v[4:7]
  ds_read_b128 v[192:195], v248 offset:16384
  s_waitcnt lgkmcnt(7)
  v_mfma_f32_16x16x32_bf16 v[8:11], v[184:187], v[208:211], v[8:11]
  ds_read_b128 v[196:199], v248 offset:18432
  v_mfma_f32_16x16x32_bf16 v[24:27], v[184:187], v[212:215], v[24:27]
  s_add_u32 s48, s48, 1
  ds_read_b64_tr_b16 v[164:165], v241 offset:16384
  s_waitcnt lgkmcnt(7)
  v_mfma_f32_16x16x32_bf16 v[28:31], v[188:191], v[212:215], v[28:31]
  s_cmp_eq_u32 s48, 3
  ds_read_b64_tr_b16 v[166:167], v245 offset:16384
  v_mfma_f32_16x16x32_bf16 v[12:15], v[188:191], v[208:211], v[12:15]
  s_cselect_b32 s49, s57, s56
  ds_read_b64_tr_b16 v[168:169], v242 offset:16384
  s_waitcnt lgkmcnt(8)
  v_mfma_f32_16x16x32_bf16 v[40:43], v[184:187], v[216:219], v[40:43]
  ds_read_b64_tr_b16 v[170:171], v246 offset:16384
  s_waitcnt lgkmcnt(8)
  v_mfma_f32_16x16x32_bf16 v[56:59], v[184:187], v[220:223], v[56:59]
  s_cselect_b32 s48, 0, s48
  ds_read_b64_tr_b16 v[172:173], v243 offset:16384
  v_mfma_f32_16x16x32_bf16 v[60:63], v[188:191], v[220:223], v[60:63]
  ds_read_b64_tr_b16 v[174:175], v247 offset:16384
  v_mfma_f32_16x16x32_bf16 v[44:47], v[188:191], v[216:219], v[44:47]
  ds_read_b128 v[200:203], v248 offset:20480
  v_mfma_f32_16x16x32_bf16 v[32:35], v[176:179], v[216:219], v[32:35]
  ds_read_b128 v[204:207], v248 offset:22528
  v_mfma_f32_16x16x32_bf16 v[48:51], v[176:179], v[220:223], v[48:51]
  v_mfma_f32_16x16x32_bf16 v[52:55], v[180:183], v[220:223], v[52:55]
  v_mfma_f32_16x16x32_bf16 v[36:39], v[180:183], v[216:219], v[36:39]
  s_barrier
  s_waitcnt lgkmcnt(9)
  v_mfma_f32_16x16x32_bf16 v[0:3], v[160:163], v[192:195], v[0:3]
  s_waitcnt lgkmcnt(8)
  v_mfma_f32_16x16x32_bf16 v[16:19], v[160:163], v[196:199], v[16:19]
  ds_read_b64_tr_b16 v[176:177], v240 offset:24576
  s_waitcnt lgkmcnt(7)
  v_mfma_f32_16x16x32_bf16 v[20:23], v[164:167], v[196:199], v[20:23]
  ds_read_b64_tr_b16 v[178:179], v244 offset:24576
  v_mfma_f32_16x16x32_bf16 v[4:7], v[164:167], v[192:195], v[4:7]
  ds_read_b128 v[208:211], v249 offset:16384
  s_waitcnt lgkmcnt(7)
  v_mfma_f32_16x16x32_bf16 v[8:11], v[168:171], v[192:195], v[8:11]
  ds_read_b128 v[212:215], v249 offset:18432
  v_mfma_f32_16x16x32_bf16 v[24:27], v[168:171], v[196:199], v[24:27]
  v_xor_b32 v248, 0x8000, v248
  ds_read_b64_tr_b16 v[180:181], v241 offset:24576
  s_waitcnt lgkmcnt(7)
  v_mfma_f32_16x16x32_bf16 v[28:31], v[172:175], v[196:199], v[28:31]
  ds_read_b64_tr_b16 v[182:183], v245 offset:24576
  v_mfma_f32_16x16x32_bf16 v[12:15], v[172:175], v[192:195], v[12:15]
  ds_read_b64_tr_b16 v[184:185], v242 offset:24576
  s_waitcnt lgkmcnt(8)
  v_mfma_f32_16x16x32_bf16 v[40:43], v[168:171], v[200:203], v[40:43]
  ds_read_b64_tr_b16 v[186:187], v246 offset:24576
  s_waitcnt lgkmcnt(8)
  v_mfma_f32_16x16x32_bf16 v[56:59], v[168:171], v[204:207], v[56:59]
  ds_read_b64_tr_b16 v[188:189], v243 offset:24576
  v_mfma_f32_16x16x32_bf16 v[60:63], v[172:175], v[204:207], v[60:63]
  v_add_u32 v240, s49, v240
  ds_read_b64_tr_b16 v[190:191], v247 offset:24576
  v_mfma_f32_16x16x32_bf16 v[44:47], v[172:175], v[200:203], v[44:47]
  v_add_u32 v244, s49, v244
  ds_read_b128 v[216:219], v249 offset:20480
  v_mfma_f32_16x16x32_bf16 v[32:35], v[160:163], v[200:203], v[32:35]
  v_add_u32 v241, s49, v241
  ds_read_b128 v[220:223], v249 offset:22528
  v_mfma_f32_16x16x32_bf16 v[48:51], v[160:163], v[204:207], v[48:51]
  v_add_u32 v245, s49, v245
  v_add_u32 v242, s49, v242
  v_mfma_f32_16x16x32_bf16 v[52:55], v[164:167], v[204:207], v[52:55]
  v_add_u32 v246, s49, v246
  v_add_u32 v243, s49, v243
  v_mfma_f32_16x16x32_bf16 v[36:39], v[164:167], v[200:203], v[36:39]
  v_add_u32 v247, s49, v247
  s_cmp_eq_u32 s47, 1
  s_cbranch_scc1 L_b31
L_b31_done:
  s_waitcnt lgkmcnt(9)
  v_mfma_f32_16x16x32_bf16 v[0:3], v[176:179], v[208:211], v[0:3]
  s_waitcnt lgkmcnt(8)
  v_mfma_f32_16x16x32_bf16 v[16:19], v[176:179], v[212:215], v[16:19]
  ds_read_b64_tr_b16 v[160:161], v240 offset:0
  s_waitcnt lgkmcnt(7)
  v_mfma_f32_16x16x32_bf16 v[20:23], v[180:183], v[212:215], v[20:23]
  ds_read_b64_tr_b16 v[162:163], v244 offset:0
  v_mfma_f32_16x16x32_bf16 v[4:7], v[180:183], v[208:211], v[4:7]
  ds_read_b128 v[192:195], v248 offset:0
  s_waitcnt lgkmcnt(7)
  v_mfma_f32_16x16x32_bf16 v[8:11], v[184:187], v[208:211], v[8:11]
  ds_read_b128 v[196:199], v248 offset:2048
  v_mfma_f32_16x16x32_bf16 v[24:27], v[184:187], v[212:215], v[24:27]
  ds_read_b64_tr_b16 v[164:165], v241 offset:0
  s_waitcnt lgkmcnt(7)
  v_mfma_f32_16x16x32_bf16 v[28:31], v[188:191], v[212:215], v[28:31]
  ds_read_b64_tr_b16 v[166:167], v245 offset:0
  v_mfma_f32_16x16x32_bf16 v[12:15], v[188:191], v[208:211], v[12:15]
  ds_read_b64_tr_b16 v[168:169], v242 offset:0
  s_waitcnt lgkmcnt(8)
  v_mfma_f32_16x16x32_bf16 v[40:43], v[184:187], v[216:219], v[40:43]
  ds_read_b64_tr_b16 v[170:171], v246 offset:0
  s_waitcnt lgkmcnt(8)
  v_mfma_f32_16x16x32_bf16 v[56:59], v[184:187], v[220:223], v[56:59]
  ds_read_b64_tr_b16 v[172:173], v243 offset:0
  v_mfma_f32_16x16x32_bf16 v[60:63], v[188:191], v[220:223], v[60:63]
  ds_read_b64_tr_b16 v[174:175], v247 offset:0
  v_mfma_f32_16x16x32_bf16 v[44:47], v[188:191], v[216:219], v[44:47]
  ds_read_b128 v[200:203], v248 offset:4096
  v_mfma_f32_16x16x32_bf16 v[32:35], v[176:179], v[216:219], v[32:35]
  ds_read_b128 v[204:207], v248 offset:6144
  v_mfma_f32_16x16x32_bf16 v[48:51], v[176:179], v[220:223], v[48:51]
  v_xor_b32 v249, 0x8000, v249
  v_mfma_f32_16x16x32_bf16 v[52:55], v[180:183], v[220:223], v[52:55]
  v_mfma_f32_16x16x32_bf16 v[36:39], v[180:183], v[216:219], v[36:39]
  s_sub_u32 s47, s47, 1
  s_cmp_lg_u32 s47, 0
  s_cbranch_scc1 L_body
  s_waitcnt vmcnt(0)
  s_cmp_lg_u32 s46, 0
  s_cbranch_scc1 L_not_first
  s_mov_b32 s60, 30000
L_verdict:
  v_readfirstlane_b32 s52, v72
  s_nop 3
  s_and_b32 s58, s52, 0x88888888
  s_cmp_eq_u32 s58, 0x88888888
  s_cbranch_scc1 L_verdict_done
  s_lshl_b32 s58, s41, 2
  s_add_u32 s58, s58, 128
  v_mov_b32 v254, s58
  s_sleep 2
  buffer_load_dword v72, v254, s[32:35], 0 offen sc1
  s_waitcnt vmcnt(0)
  s_sub_u32 s60, s60, 1
  s_cmp_lg_u32 s60, 0
  s_cbranch_scc1 L_verdict
L_verdict_done:
  s_and_b32 s58, s52, 15
  s_mul_i32 s58, s58, 0x11111111
  s_cmp_eq_u32 s52, s58
  s_cselect_b32 s50, 1, 0
  v_lshlrev_b32 v254, 7, v252
  v_sub_u32 v240, v240, v254
  v_sub_u32 v244, v244, v254
  v_add_u32 v244, 3072, v244
  v_sub_u32 v241, v241, v254
  v_sub_u32 v245, v245, v254
  v_add_u32 v245, 3072, v245
  v_sub_u32 v242, v242, v254
  v_sub_u32 v246, v246, v254
  v_add_u32 v246, 3072, v246
  v_sub_u32 v243, v243, v254
  v_sub_u32 v247, v247, v254
  v_add_u32 v247, 3072, v247
  s_lshl_b32 s52, s45, 14
  v_subrev_u32 v248, s52, v250
  v_add_u32 v249, 1024, v248
  v_lshlrev_b32 v64, 16, v128
  v_and_b32 v65, 0xffff0000, v128
  v_lshlrev_b32 v66, 16, v129
  v_and_b32 v67, 0xffff0000, v129
  v_lshlrev_b32 v68, 16, v130
  v_and_b32 v69, 0xffff0000, v130
  v_lshlrev_b32 v70, 16, v131
  v_and_b32 v71, 0xffff0000, v131
  v_lshlrev_b32 v72, 16, v144
  v_and_b32 v73, 0xffff0000, v144
  v_lshlrev_b32 v74, 16, v145
  v_and_b32 v75, 0xffff0000, v145
  v_lshlrev_b32 v76, 16, v146
  v_and_b32 v77, 0xffff0000, v146
  v_lshlrev_b32 v78, 16, v147
  v_and_b32 v79, 0xffff0000, v147
  v_lshlrev_b32 v80, 16, v132
  v_and_b32 v81, 0xffff0000, v132
  v_lshlrev_b32 v82, 16, v133
  v_and_b32 v83, 0xffff0000, v133
  v_lshlrev_b32 v84, 16, v134
  v_and_b32 v85, 0xffff0000, v134
  v_lshlrev_b32 v86, 16, v135
  v_and_b32 v87, 0xffff0000, v135
  v_lshlrev_b32 v88, 16, v148
  v_and_b32 v89, 0xffff0000, v148
  v_lshlrev_b32 v90, 16, v149
  v_and_b32 v91, 0xffff0000, v149
  v_lshlrev_b32 v92, 16, v150
  v_and_b32 v93, 0xffff0000, v150
  v_lshlrev_b32 v94, 16, v151
  v_and_b32 v95, 0xffff0000, v151
  v_lshlrev_b32 v96, 16, v136
  v_and_b32 v97, 0xffff0000, v136
  v_lshlrev_b32 v98, 16, v137
  v_and_b32 v99, 0xffff0000, v137
  v_lshlrev_b32 v100, 16, v138
  v_and_b32 v101, 0xffff0000, v138
  v_lshlrev_b32 v102, 16, v139
  v_and_b32 v103, 0xffff0000, v139
  v_lshlrev_b32 v104, 16, v152
  v_and_b32 v105, 0xffff0000, v152
  v_lshlrev_b32 v106, 16, v153
  v_and_b32 v107, 0xffff0000, v153
  v_lshlrev_b32 v108, 16, v154
  v_and_b32 v109, 0xffff0000, v154
  v_lshlrev_b32 v110, 16, v155
  v_and_b32 v111, 0xffff0000, v155
  v_lshlrev_b32 v112, 16, v140
  v_and_b32 v113, 0xffff0000, v140
  v_lshlrev_b32 v114, 16, v141
  v_and_b32 v115, 0xffff0000, v141
  v_lshlrev_b32 v116, 16, v142
  v_and_b32 v117, 0xffff0000, v142
  v_lshlrev_b32 v118, 16, v143
  v_and_b32 v119, 0xffff0000, v143
  v_lshlrev_b32 v120, 16, v156
  v_and_b32 v121, 0xffff0000, v156
  v_lshlrev_b32 v122, 16, v157
  v_and_b32 v123, 0xffff0000, v157
  v_lshlrev_b32 v124, 16, v158
  v_and_b32 v125, 0xffff0000, v158
  v_lshlrev_b32 v126, 16, v159
  v_and_b32 v127, 0xffff0000, v159
L_not_first:
  s_add_u32 s46, s46, 1
  s_cmp_eq_u32 s46, 6
  s_cbranch_scc1 L_final
  s_cmp_eq_u32 s50, 0
  s_cbranch_scc1 L_epi_slow
  s_mov_b32 s52, s51
  s_add_u32 s53, s51, 4096
  s_lshl_b32 s58, s46, 1
  s_sub_u32 s58, s58, 1
  v_mov_b32 v254, s58
  v_lshlrev_b32 v208, 16, v128
  v_and_b32 v209, 0xffff0000, v128
  v_lshlrev_b32 v210, 16, v129
  v_and_b32 v211, 0xffff0000, v129
  v_lshlrev_b32 v212, 16, v130
  v_and_b32 v213, 0xffff0000, v130
  v_lshlrev_b32 v214, 16, v131
  v_and_b32 v215, 0xffff0000, v131
  v_pk_fma_f32 v[208:209], v[64:65], v[0:1], v[208:209]
  v_pk_fma_f32 v[210:211], v[66:67], v[2:3], v[210:211]
  v_pk_fma_f32 v[212:213], v[68:69], v[4:5], v[212:213]
  v_pk_fma_f32 v[214:215], v[70:71], v[6:7], v[214:215]
  v_cvt_pk_bf16_f32 v128, v208, v209
  v_cvt_pk_bf16_f32 v129, v210, v211
  v_cvt_pk_bf16_f32 v130, v212, v213
  v_cvt_pk_bf16_f32 v131, v214, v215
  ds_write_b128 v250, v[128:131] offset:0
  buffer_store_dwordx4 v[128:131], v250, s[36:39], s52 offen offset:0
  v_lshlrev_b32 v208, 16, v132
  v_and_b32 v209, 0xffff0000, v132
  v_lshlrev_b32 v210, 16, v133
  v_and_b32 v211, 0xffff0000, v133
  v_lshlrev_b32 v212, 16, v134
  v_and_b32 v213, 0xffff0000, v134
  v_lshlrev_b32 v214, 16, v135
  v_and_b32 v215, 0xffff0000, v135
  v_pk_fma_f32 v[208:209], v[80:81], v[16:17], v[208:209]
  v_pk_fma_f32 v[210:211], v[82:83], v[18:19], v[210:211]
  v_pk_fma_f32 v[212:213], v[84:85], v[20:21], v[212:213]
  v_pk_fma_f32 v[214:215], v[86:87], v[22:23], v[214:215]
  v_cvt_pk_bf16_f32 v132, v208, v209
  v_cvt_pk_bf16_f32 v133, v210, v211
  v_cvt_pk_bf16_f32 v134, v212, v213
  v_cvt_pk_bf16_f32 v135, v214, v215
  ds_write_b128 v250, v[132:135] offset:2048
  buffer_store_dwordx4 v[132:135], v250, s[36:39], s52 offen offset:2048
  v_lshlrev_b32 v208, 16, v136
  v_and_b32 v209, 0xffff0000, v136
  v_lshlrev_b32 v210, 16, v137
  v_and_b32 v211, 0xffff0000, v137
  v_lshlrev_b32 v212, 16, v138
  v_and_b32 v213, 0xffff0000, v138
  v_lshlrev_b32 v214, 16, v139
  v_and_b32 v215, 0xffff0000, v139
  v_pk_fma_f32 v[208:209], v[96:97], v[32:33], v[208:209]
  v_pk_fma_f32 v[210:211], v[98:99], v[34:35], v[210:211]
  v_pk_fma_f32 v[212:213], v[100:101], v[36:37], v[212:213]
  v_pk_fma_f32 v[214:215], v[102:103], v[38:39], v[214:215]
  v_cvt_pk_bf16_f32 v136, v208, v209
  v_cvt_pk_bf16_f32 v137, v210, v211
  v_cvt_pk_bf16_f32 v138, v212, v213
  v_cvt_pk_bf16_f32 v139, v214, v215
  ds_write_b128 v250, v[136:139] offset:4096
  buffer_store_dwordx4 v[136:139], v250, s[36:39], s53 offen offset:0
  v_lshlrev_b32 v208, 16, v140
  v_and_b32 v209, 0xffff0000, v140
  v_lshlrev_b32 v210, 16, v141
  v_and_b32 v211, 0xffff0000, v141
  v_lshlrev_b32 v212, 16, v142
  v_and_b32 v213, 0xffff0000, v142
  v_lshlrev_b32 v214, 16, v143
  v_and_b32 v215, 0xffff0000, v143
  v_pk_fma_f32 v[208:209], v[112:113], v[48:49], v[208:209]
  v_pk_fma_f32 v[210:211], v[114:115], v[50:51], v[210:211]
  v_pk_fma_f32 v[212:213], v[116:117], v[52:53], v[212:213]
  v_pk_fma_f32 v[214:215], v[118:119], v[54:55], v[214:215]
  v_cvt_pk_bf16_f32 v140, v208, v209
  v_cvt_pk_bf16_f32 v141, v210, v211
  v_cvt_pk_bf16_f32 v142, v212, v213
  v_cvt_pk_bf16_f32 v143, v214, v215
  ds_write_b128 v250, v[140:143] offset:6144
  buffer_store_dwordx4 v[140:143], v250, s[36:39], s53 offen offset:2048
  v_lshlrev_b32 v216, 16, v144
  v_and_b32 v217, 0xffff0000, v144
  v_lshlrev_b32 v218, 16, v145
  v_and_b32 v219, 0xffff0000, v145
  v_lshlrev_b32 v220, 16, v146
  v_and_b32 v221, 0xffff0000, v146
  v_lshlrev_b32 v222, 16, v147
  v_and_b32 v223, 0xffff0000, v147
  v_pk_fma_f32 v[216:217], v[72:73], v[8:9], v[216:217]
  v_pk_fma_f32 v[218:219], v[74:75], v[10:11], v[218:219]
  v_pk_fma_f32 v[220:221], v[76:77], v[12:13], v[220:221]
  v_pk_fma_f32 v[222:223], v[78:79], v[14:15], v[222:223]
  v_cvt_pk_bf16_f32 v144, v216, v217
  v_cvt_pk_bf16_f32 v145, v218, v219
  v_cvt_pk_bf16_f32 v146, v220, v221
  v_cvt_pk_bf16_f32 v147, v222, v223
  ds_write_b128 v250, v[144:147] offset:1024
  buffer_store_dwordx4 v[144:147], v250, s[36:39], s52 offen offset:1024
  v_lshlrev_b32 v216, 16, v148
  v_and_b32 v217, 0xffff0000, v148
  v_lshlrev_b32 v218, 16, v149
  v_and_b32 v219, 0xffff0000, v149
  v_lshlrev_b32 v220, 16, v150
  v_and_b32 v221, 0xffff0000, v150
  v_lshlrev_b32 v222, 16, v151
  v_and_b32 v223, 0xffff0000, v151
  v_pk_fma_f32 v[216:217], v[88:89], v[24:25], v[216:217]
  v_pk_fma_f32 v[218:219], v[90:91], v[26:27], v[218:219]
  v_pk_fma_f32 v[220:221], v[92:93], v[28:29], v[220:221]
  v_pk_fma_f32 v[222:223], v[94:95], v[30:31], v[222:223]
  v_cvt_pk_bf16_f32 v148, v216, v217
  v_cvt_pk_bf16_f32 v149, v218, v219
  v_cvt_pk_bf16_f32 v150, v220, v221
  v_cvt_pk_bf16_f32 v151, v222, v223
  ds_write_b128 v250, v[148:151] offset:3072
  buffer_store_dwordx4 v[148:151], v250, s[36:39], s52 offen offset:3072
  v_lshlrev_b32 v216, 16, v152
  v_and_b32 v217, 0xffff0000, v152
  v_lshlrev_b32 v218, 16, v153
  v_and_b32 v219, 0xffff0000, v153
  v_lshlrev_b32 v220, 16, v154
  v_and_b32 v221, 0xffff0000, v154
  v_lshlrev_b32 v222, 16, v155
  v_and_b32 v223, 0xffff0000, v155
  v_pk_fma_f32 v[216:217], v[104:105], v[40:41], v[216:217]
  v_pk_fma_f32 v[218:219], v[106:107], v[42:43], v[218:219]
  v_pk_fma_f32 v[220:221], v[108:109], v[44:45], v[220:221]
  v_pk_fma_f32 v[222:223], v[110:111], v[46:47], v[222:223]
  v_cvt_pk_bf16_f32 v152, v216, v217
  v_cvt_pk_bf16_f32 v153, v218, v219
  v_cvt_pk_bf16_f32 v154, v220, v221
  v_cvt_pk_bf16_f32 v155, v222, v223
  ds_write_b128 v250, v[152:155] offset:5120
  buffer_store_dwordx4 v[152:155], v250, s[36:39], s53 offen offset:1024
  s_waitcnt vmcnt(3)
  buffer_store_dword v254, v253, s[36:39], 0 offen
  v_lshlrev_b32 v216, 16, v156
  v_and_b32 v217, 0xffff0000, v156
  v_lshlrev_b32 v218, 16, v157
  v_and_b32 v219, 0xffff0000, v157
  v_lshlrev_b32 v220, 16, v158
  v_and_b32 v221, 0xffff0000, v158
  v_lshlrev_b32 v222, 16, v159
  v_and_b32 v223, 0xffff0000, v159
  v_pk_fma_f32 v[216:217], v[120:121], v[56:57], v[216:217]
  v_pk_fma_f32 v[218:219], v[122:123], v[58:59], v[218:219]
  v_pk_fma_f32 v[220:221], v[124:125], v[60:61], v[220:221]
  v_pk_fma_f32 v[222:223], v[126:127], v[62:63], v[222:223]
  v_cvt_pk_bf16_f32 v156, v216, v217
  v_cvt_pk_bf16_f32 v157, v218, v219
  v_cvt_pk_bf16_f32 v158, v220, v221
  v_cvt_pk_bf16_f32 v159, v222, v223
  ds_write_b128 v250, v[156:159] offset:7168
  buffer_store_dwordx4 v[156:159], v250, s[36:39], s53 offen offset:3072
  s_branch L_layer
L_final:
  v_and_b32 v254, 0x3ff, v250
  v_lshrrev_b32 v254, 4, v254
  v_and_b32 v240, 15, v254
  v_lshrrev_b32 v241, 5, v254
  v_xor_b32 v241, v241, v240
  v_and_b32 v241, 7, v241
  v_lshlrev_b32 v241, 4, v241
  v_lshl_add_u32 v240, v240, 7, v241
  v_bfe_u32 v241, v254, 4, 1
  v_lshl_add_u32 v240, v241, 3, v240
  s_lshl_b32 s52, s40, 13
  v_add_u32 v240, s52, v240
  v_lshrrev_b32 v241, 3, v254
  v_and_b32 v242, 7, v254
  v_xor_b32 v243, v242, v241
  v_lshlrev_b32 v243, 4, v243
  v_lshlrev_b32 v242, 4, v242
  v_lshl_add_u32 v242, v241, 11, v242
  v_lshl_add_u32 v241, v241, 7, v243
  v_add_u32 v241, s52, v241
  v_xor_b32 v245, 32, v240
  v_xor_b32 v246, 64, v240
  v_xor_b32 v247, 96, v240
  v_mov_b32 v244, v240
  v_lshlrev_b32 v208, 16, v128
  v_and_b32 v209, 0xffff0000, v128
  v_lshlrev_b32 v210, 16, v129
  v_and_b32 v211, 0xffff0000, v129
  v_lshlrev_b32 v212, 16, v130
  v_and_b32 v213, 0xffff0000, v130
  v_lshlrev_b32 v214, 16, v131
  v_and_b32 v215, 0xffff0000, v131
  v_pk_fma_f32 v[208:209], v[64:65], v[0:1], v[208:209]
  v_pk_fma_f32 v[210:211], v[66:67], v[2:3], v[210:211]
  v_pk_fma_f32 v[212:213], v[68:69], v[4:5], v[212:213]
  v_pk_fma_f32 v[214:215], v[70:71], v[6:7], v[214:215]
  v_cvt_pk_bf16_f32 v128, v208, v209
  v_cvt_pk_bf16_f32 v129, v210, v211
  v_cvt_pk_bf16_f32 v130, v212, v213
  v_cvt_pk_bf16_f32 v131, v214, v215
  ds_write_b64 v244, v[128:129] offset:0
  ds_write_b64 v245, v[130:131] offset:0
  v_lshlrev_b32 v216, 16, v144
  v_and_b32 v217, 0xffff0000, v144
  v_lshlrev_b32 v218, 16, v145
  v_and_b32 v219, 0xffff0000, v145
  v_lshlrev_b32 v220, 16, v146
  v_and_b32 v221, 0xffff0000, v146
  v_lshlrev_b32 v222, 16, v147
  v_and_b32 v223, 0xffff0000, v147
  v_pk_fma_f32 v[216:217], v[72:73], v[8:9], v[216:217]
  v_pk_fma_f32 v[218:219], v[74:75], v[10:11], v[218:219]
  v_pk_fma_f32 v[220:221], v[76:77], v[12:13], v[220:221]
  v_pk_fma_f32 v[222:223], v[78:79], v[14:15], v[222:223]
  v_cvt_pk_bf16_f32 v144, v216, v217
  v_cvt_pk_bf16_f32 v145, v218, v219
  v_cvt_pk_bf16_f32 v146, v220, v221
  v_cvt_pk_bf16_f32 v147, v222, v223
  ds_write_b64 v246, v[144:145] offset:0
  ds_write_b64 v247, v[146:147] offset:0
  ds_read_b128 v[160:163], v241 offset:0
  ds_read_b128 v[164:167], v241 offset:1024
  v_lshlrev_b32 v208, 16, v132
  v_and_b32 v209, 0xffff0000, v132
  v_lshlrev_b32 v210, 16, v133
  v_and_b32 v211, 0xffff0000, v133
  v_lshlrev_b32 v212, 16, v134
  v_and_b32 v213, 0xffff0000, v134
  v_lshlrev_b32 v214, 16, v135
  v_and_b32 v215, 0xffff0000, v135
  v_pk_fma_f32 v[208:209], v[80:81], v[16:17], v[208:209]
  v_pk_fma_f32 v[210:211], v[82:83], v[18:19], v[210:211]
  v_pk_fma_f32 v[212:213], v[84:85], v[20:21], v[212:213]
  v_pk_fma_f32 v[214:215], v[86:87], v[22:23], v[214:215]
  v_cvt_pk_bf16_f32 v132, v208, v209
  v_cvt_pk_bf16_f32 v133, v210, v211
  v_cvt_pk_bf16_f32 v134, v212, v213
  v_cvt_pk_bf16_f32 v135, v214, v215
  ds_write_b64 v244, v[132:133] offset:2048
  ds_write_b64 v245, v[134:135] offset:2048
  v_lshlrev_b32 v216, 16, v148
  v_and_b32 v217, 0xffff0000, v148
  v_lshlrev_b32 v218, 16, v149
  v_and_b32 v219, 0xffff0000, v149
  v_lshlrev_b32 v220, 16, v150
  v_and_b32 v221, 0xffff0000, v150
  v_lshlrev_b32 v222, 16, v151
  v_and_b32 v223, 0xffff0000, v151
  v_pk_fma_f32 v[216:217], v[88:89], v[24:25], v[216:217]
  v_pk_fma_f32 v[218:219], v[90:91], v[26:27], v[218:219]
  v_pk_fma_f32 v[220:221], v[92:93], v[28:29], v[220:221]
  v_pk_fma_f32 v[222:223], v[94:95], v[30:31], v[222:223]
  v_cvt_pk_bf16_f32 v148, v216, v217
  v_cvt_pk_bf16_f32 v149, v218, v219
  v_cvt_pk_bf16_f32 v150, v220, v221
  v_cvt_pk_bf16_f32 v151, v222, v223
  ds_write_b64 v246, v[148:149] offset:2048
  ds_write_b64 v247, v[150:151] offset:2048
  ds_read_b128 v[168:171], v241 offset:2048
  ds_read_b128 v[172:175], v241 offset:3072
  s_waitcnt lgkmcnt(7)
  s_add_u32 s52, s55, 0
  buffer_store_dwordx4 v[160:163], v242, s[28:31], s52 offen
  s_waitcnt lgkmcnt(6)
  s_add_u32 s52, s55, 16384
  buffer_store_dwordx4 v[164:167], v242, s[28:31], s52 offen
  v_lshlrev_b32 v208, 16, v136
  v_and_b32 v209, 0xffff0000, v136
  v_lshlrev_b32 v210, 16, v137
  v_and_b32 v211, 0xffff0000, v137
  v_lshlrev_b32 v212, 16, v138
  v_and_b32 v213, 0xffff0000, v138
  v_lshlrev_b32 v214, 16, v139
  v_and_b32 v215, 0xffff0000, v139
  v_pk_fma_f32 v[208:209], v[96:97], v[32:33], v[208:209]
  v_pk_fma_f32 v[210:211], v[98:99], v[34:35], v[210:211]
  v_pk_fma_f32 v[212:213], v[100:101], v[36:37], v[212:213]
  v_pk_fma_f32 v[214:215], v[102:103], v[38:39], v[214:215]
  v_cvt_pk_bf16_f32 v136, v208, v209
  v_cvt_pk_bf16_f32 v137, v210, v211
  v_cvt_pk_bf16_f32 v138, v212, v213
  v_cvt_pk_bf16_f32 v139, v214, v215
  ds_write_b64 v244, v[136:137] offset:4096
  ds_write_b64 v245, v[138:139] offset:4096
  v_lshlrev_b32 v216, 16, v152
  v_and_b32 v217, 0xffff0000, v152
  v_lshlrev_b32 v218, 16, v153
  v_and_b32 v219, 0xffff0000, v153
  v_lshlrev_b32 v220, 16, v154
  v_and_b32 v221, 0xffff0000, v154
  v_lshlrev_b32 v222, 16, v155
  v_and_b32 v223, 0xffff0000, v155
  v_pk_fma_f32 v[216:217], v[104:105], v[40:41], v[216:217]
  v_pk_fma_f32 v[218:219], v[106:107], v[42:43], v[218:219]
  v_pk_fma_f32 v[220:221], v[108:109], v[44:45], v[220:221]
  v_pk_fma_f32 v[222:223], v[110:111], v[46:47], v[222:223]
  v_cvt_pk_bf16_f32 v152, v216, v217
  v_cvt_pk_bf16_f32 v153, v218, v219
  v_cvt_pk_bf16_f32 v154, v220, v221
  v_cvt_pk_bf16_f32 v155, v222, v223
  ds_write_b64 v246, v[152:153] offset:4096
  ds_write_b64 v247, v[154:155] offset:4096
  ds_read_b128 v[176:179], v241 offset:4096
  ds_read_b128 v[180:183], v241 offset:5120
  s_waitcnt lgkmcnt(7)
  s_add_u32 s52, s55, 32768
  buffer_store_dwordx4 v[168:171], v242, s[28:31], s52 offen
  s_waitcnt lgkmcnt(6)
  s_add_u32 s52, s55, 49152
  buffer_store_dwordx4 v[172:175], v242, s[28:31], s52 offen
  v_lshlrev_b32 v208, 16, v140
  v_and_b32 v209, 0xffff0000, v140
  v_lshlrev_b32 v210, 16, v141
  v_and_b32 v211, 0xffff0000, v141
  v_lshlrev_b32 v212, 16, v142
  v_and_b32 v213, 0xffff0000, v142
  v_lshlrev_b32 v214, 16, v143
  v_and_b32 v215, 0xffff0000, v143
  v_pk_fma_f32 v[208:209], v[112:113], v[48:49], v[208:209]
  v_pk_fma_f32 v[210:211], v[114:115], v[50:51], v[210:211]
  v_pk_fma_f32 v[212:213], v[116:117], v[52:53], v[212:213]
  v_pk_fma_f32 v[214:215], v[118:119], v[54:55], v[214:215]
  v_cvt_pk_bf16_f32 v140, v208, v209
  v_cvt_pk_bf16_f32 v141, v210, v211
  v_cvt_pk_bf16_f32 v142, v212, v213
  v_cvt_pk_bf16_f32 v143, v214, v215
  ds_write_b64 v244, v[140:141] offset:6144
  ds_write_b64 v245, v[142:143] offset:6144
  v_lshlrev_b32 v216, 16, v156
  v_and_b32 v217, 0xffff0000, v156
  v_lshlrev_b32 v218, 16, v157
  v_and_b32 v219, 0xffff0000, v157
  v_lshlrev_b32 v220, 16, v158
  v_and_b32 v221, 0xffff0000, v158
  v_lshlrev_b32 v222, 16, v159
  v_and_b32 v223, 0xffff0000, v159
  v_pk_fma_f32 v[216:217], v[120:121], v[56:57], v[216:217]
  v_pk_fma_f32 v[218:219], v[122:123], v[58:59], v[218:219]
  v_pk_fma_f32 v[220:221], v[124:125], v[60:61], v[220:221]
  v_pk_fma_f32 v[222:223], v[126:127], v[62:63], v[222:223]
  v_cvt_pk_bf16_f32 v156, v216, v217
  v_cvt_pk_bf16_f32 v157, v218, v219
  v_cvt_pk_bf16_f32 v158, v220, v221
  v_cvt_pk_bf16_f32 v159, v222, v223
  ds_write_b64 v246, v[156:157] offset:6144
  ds_write_b64 v247, v[158:159] offset:6144
  ds_read_b128 v[184:187], v241 offset:6144
  ds_read_b128 v[188:191], v241 offset:7168
  s_waitcnt lgkmcnt(7)
  s_add_u32 s52, s55, 65536
  buffer_store_dwordx4 v[176:179], v242, s[28:31], s52 offen
  s_waitcnt lgkmcnt(6)
  s_add_u32 s52, s55, 81920
  buffer_store_dwordx4 v[180:183], v242, s[28:31], s52 offen
  s_waitcnt lgkmcnt(1)
  s_add_u32 s52, s55, 98304
  buffer_store_dwordx4 v[184:187], v242, s[28:31], s52 offen
  s_waitcnt lgkmcnt(0)
  s_add_u32 s52, s55, 114688
  buffer_store_dwordx4 v[188:191], v242, s[28:31], s52 offen
  s_waitcnt vmcnt(0)
  s_endpgm
L_b5:
  buffer_load_dwordx2 v[232:233], v252, s[24:27], s54 offen offset:0
  buffer_load_dwordx2 v[234:235], v252, s[24:27], s54 offen offset:32
  buffer_load_dwordx2 v[236:237], v252, s[24:27], s54 offen offset:64
  buffer_load_dwordx2 v[238:239], v252, s[24:27], s54 offen offset:96
  s_barrier
  s_branch L_b5_done
L_b31:
  s_waitcnt vmcnt(0)
  v_lshlrev_b32 v224, 16, v232
  v_and_b32 v225, 0xffff0000, v232
  v_lshlrev_b32 v226, 16, v233
  v_and_b32 v227, 0xffff0000, v233
  v_lshlrev_b32 v228, 16, v234
  v_and_b32 v229, 0xffff0000, v234
  v_lshlrev_b32 v230, 16, v235
  v_and_b32 v231, 0xffff0000, v235
  v_lshlrev_b32 v232, 16, v236
  v_and_b32 v233, 0xffff0000, v236
  v_lshlrev_b32 v234, 16, v237
  v_and_b32 v235, 0xffff0000, v237
  v_lshlrev_b32 v236, 16, v238
  v_and_b32 v237, 0xffff0000, v238
  v_lshlrev_b32 v238, 16, v239
  v_and_b32 v239, 0xffff0000, v239
  s_barrier
  s_branch L_b31_done
L_first_b1:
  s_barrier
  v_and_b32 v254, 0x3ff, v250
  v_lshrrev_b32 v254, 4, v254
  v_and_b32 v64, 15, v254
  v_lshrrev_b32 v65, 5, v254
  v_lshrrev_b32 v66, 1, v64
  v_xor_b32 v65, v65, v66
  v_lshlrev_b32 v65, 4, v65
  v_lshl_add_u32 v65, v64, 7, v65
  v_bfe_u32 v66, v254, 4, 1
  v_lshl_add_u32 v65, v66, 3, v65
  v_and_b32 v66, 0x7c00, v250
  v_add_u32 v65, v65, v66
  v_xor_b32 v68, 0, v65
  v_xor_b32 v69, 32, v65
  v_xor_b32 v70, 64, v65
  v_xor_b32 v71, 96, v65
  ds_read_b64 v[128:129], v68 offset:0
  ds_read_b64 v[130:131], v69 offset:0
  ds_read_b64 v[144:145], v70 offset:0
  ds_read_b64 v[146:147], v71 offset:0
  ds_read_b64 v[132:133], v68 offset:2048
  ds_read_b64 v[134:135], v69 offset:2048
  ds_read_b64 v[148:149], v70 offset:2048
  ds_read_b64 v[150:151], v71 offset:2048
  ds_read_b64 v[136:137], v68 offset:4096
  ds_read_b64 v[138:139], v69 offset:4096
  ds_read_b64 v[152:153], v70 offset:4096
  ds_read_b64 v[154:155], v71 offset:4096
  ds_read_b64 v[140:141], v68 offset:6144
  ds_read_b64 v[142:143], v69 offset:6144
  ds_read_b64 v[156:157], v70 offset:6144
  ds_read_b64 v[158:159], v71 offset:6144
  s_waitcnt lgkmcnt(0)
  s_branch L_first_b1_done
L_first_b2:
  s_barrier
  s_branch L_first_b2_done
L_first_own:
  s_lshl_b32 s52, s41, 2
  s_add_u32 s52, s52, 128
  v_mov_b32 v254, s52
  buffer_load_dword v72, v254, s[32:35], 0 offen sc1
  s_branch L_first_own_done
L_flag_slow:
  buffer_store_dword v254, v253, s[36:39], 0 offen sc1
  s_branch L_flag_done
L_epi_slow:
  s_add_u32 s51, s51, 0x800000
  s_mov_b32 s52, s51
  s_add_u32 s53, s51, 4096
  s_lshl_b32 s58, s46, 1
  s_sub_u32 s58, s58, 1
  v_mov_b32 v254, s58
  v_lshlrev_b32 v208, 16, v128
  v_and_b32 v209, 0xffff0000, v128
  v_lshlrev_b32 v210, 16, v129
  v_and_b32 v211, 0xffff0000, v129
  v_lshlrev_b32 v212, 16, v130
  v_and_b32 v213, 0xffff0000, v130
  v_lshlrev_b32 v214, 16, v131
  v_and_b32 v215, 0xffff0000, v131
  v_pk_fma_f32 v[208:209], v[64:65], v[0:1], v[208:209]
  v_pk_fma_f32 v[210:211], v[66:67], v[2:3], v[210:211]
  v_pk_fma_f32 v[212:213], v[68:69], v[4:5], v[212:213]
  v_pk_fma_f32 v[214:215], v[70:71], v[6:7], v[214:215]
  v_cvt_pk_bf16_f32 v128, v208, v209
  v_cvt_pk_bf16_f32 v129, v210, v211
  v_cvt_pk_bf16_f32 v130, v212, v213
  v_cvt_pk_bf16_f32 v131, v214, v215
  ds_write_b128 v250, v[128:131] offset:0
  buffer_store_dwordx4 v[128:131], v250, s[36:39], s52 offen offset:0 sc1
  v_lshlrev_b32 v208, 16, v132
  v_and_b32 v209, 0xffff0000, v132
  v_lshlrev_b32 v210, 16, v133
  v_and_b32 v211, 0xffff0000, v133
  v_lshlrev_b32 v212, 16, v134
  v_and_b32 v213, 0xffff0000, v134
  v_lshlrev_b32 v214, 16, v135
  v_and_b32 v215, 0xffff0000, v135
  v_pk_fma_f32 v[208:209], v[80:81], v[16:17], v[208:209]
  v_pk_fma_f32 v[210:211], v[82:83], v[18:19], v[210:211]
  v_pk_fma_f32 v[212:213], v[84:85], v[20:21], v[212:213]
  v_pk_fma_f32 v[214:215], v[86:87], v[22:23], v[214:215]
  v_cvt_pk_bf16_f32 v132, v208, v209
  v_cvt_pk_bf16_f32 v133, v210, v211
  v_cvt_pk_bf16_f32 v134, v212, v213
  v_cvt_pk_bf16_f32 v135, v214, v215
  ds_write_b128 v250, v[132:135] offset:2048
  buffer_store_dwordx4 v[132:135], v250, s[36:39], s52 offen offset:2048 sc1
  v_lshlrev_b32 v208, 16, v136
  v_and_b32 v209, 0xffff0000, v136
  v_lshlrev_b32 v210, 16, v137
  v_and_b32 v211, 0xffff0000, v137
  v_lshlrev_b32 v212, 16, v138
  v_and_b32 v213, 0xffff0000, v138
  v_lshlrev_b32 v214, 16, v139
  v_and_b32 v215, 0xffff0000, v139
  v_pk_fma_f32 v[208:209], v[96:97], v[32:33], v[208:209]
  v_pk_fma_f32 v[210:211], v[98:99], v[34:35], v[210:211]
  v_pk_fma_f32 v[212:213], v[100:101], v[36:37], v[212:213]
  v_pk_fma_f32 v[214:215], v[102:103], v[38:39], v[214:215]
  v_cvt_pk_bf16_f32 v136, v208, v209
  v_cvt_pk_bf16_f32 v137, v210, v211
  v_cvt_pk_bf16_f32 v138, v212, v213
  v_cvt_pk_bf16_f32 v139, v214, v215
  ds_write_b128 v250, v[136:139] offset:4096
  buffer_store_dwordx4 v[136:139], v250, s[36:39], s53 offen offset:0 sc1
  v_lshlrev_b32 v208, 16, v140
  v_and_b32 v209, 0xffff0000, v140
  v_lshlrev_b32 v210, 16, v141
  v_and_b32 v211, 0xffff0000, v141
  v_lshlrev_b32 v212, 16, v142
  v_and_b32 v213, 0xffff0000, v142
  v_lshlrev_b32 v214, 16, v143
  v_and_b32 v215, 0xffff0000, v143
  v_pk_fma_f32 v[208:209], v[112:113], v[48:49], v[208:209]
  v_pk_fma_f32 v[210:211], v[114:115], v[50:51], v[210:211]
  v_pk_fma_f32 v[212:213], v[116:117], v[52:53], v[212:213]
  v_pk_fma_f32 v[214:215], v[118:119], v[54:55], v[214:215]
  v_cvt_pk_bf16_f32 v140, v208, v209
  v_cvt_pk_bf16_f32 v141, v210, v211
  v_cvt_pk_bf16_f32 v142, v212, v213
  v_cvt_pk_bf16_f32 v143, v214, v215
  ds_write_b128 v250, v[140:143] offset:6144
  buffer_store_dwordx4 v[140:143], v250, s[36:39], s53 offen offset:2048 sc1
  v_lshlrev_b32 v216, 16, v144
  v_and_b32 v217, 0xffff0000, v144
  v_lshlrev_b32 v218, 16, v145
  v_and_b32 v219, 0xffff0000, v145
  v_lshlrev_b32 v220, 16, v146
  v_and_b32 v221, 0xffff0000, v146
  v_lshlrev_b32 v222, 16, v147
  v_and_b32 v223, 0xffff0000, v147
  v_pk_fma_f32 v[216:217], v[72:73], v[8:9], v[216:217]
  v_pk_fma_f32 v[218:219], v[74:75], v[10:11], v[218:219]
  v_pk_fma_f32 v[220:221], v[76:77], v[12:13], v[220:221]
  v_pk_fma_f32 v[222:223], v[78:79], v[14:15], v[222:223]
  v_cvt_pk_bf16_f32 v144, v216, v217
  v_cvt_pk_bf16_f32 v145, v218, v219
  v_cvt_pk_bf16_f32 v146, v220, v221
  v_cvt_pk_bf16_f32 v147, v222, v223
  ds_write_b128 v250, v[144:147] offset:1024
  buffer_store_dwordx4 v[144:147], v250, s[36:39], s52 offen offset:1024 sc1
  v_lshlrev_b32 v216, 16, v148
  v_and_b32 v217, 0xffff0000, v148
  v_lshlrev_b32 v218, 16, v149
  v_and_b32 v219, 0xffff0000, v149
  v_lshlrev_b32 v220, 16, v150
  v_and_b32 v221, 0xffff0000, v150
  v_lshlrev_b32 v222, 16, v151
  v_and_b32 v223, 0xffff0000, v151
  v_pk_fma_f32 v[216:217], v[88:89], v[24:25], v[216:217]
  v_pk_fma_f32 v[218:219], v[90:91], v[26:27], v[218:219]
  v_pk_fma_f32 v[220:221], v[92:93], v[28:29], v[220:221]
  v_pk_fma_f32 v[222:223], v[94:95], v[30:31], v[222:223]
  v_cvt_pk_bf16_f32 v148, v216, v217
  v_cvt_pk_bf16_f32 v149, v218, v219
  v_cvt_pk_bf16_f32 v150, v220, v221
  v_cvt_pk_bf16_f32 v151, v222, v223
  ds_write_b128 v250, v[148:151] offset:3072
  buffer_store_dwordx4 v[148:151], v250, s[36:39], s52 offen offset:3072 sc1
  v_lshlrev_b32 v216, 16, v152
  v_and_b32 v217, 0xffff0000, v152
  v_lshlrev_b32 v218, 16, v153
  v_and_b32 v219, 0xffff0000, v153
  v_lshlrev_b32 v220, 16, v154
  v_and_b32 v221, 0xffff0000, v154
  v_lshlrev_b32 v222, 16, v155
  v_and_b32 v223, 0xffff0000, v155
  v_pk_fma_f32 v[216:217], v[104:105], v[40:41], v[216:217]
  v_pk_fma_f32 v[218:219], v[106:107], v[42:43], v[218:219]
  v_pk_fma_f32 v[220:221], v[108:109], v[44:45], v[220:221]
  v_pk_fma_f32 v[222:223], v[110:111], v[46:47], v[222:223]
  v_cvt_pk_bf16_f32 v152, v216, v217
  v_cvt_pk_bf16_f32 v153, v218, v219
  v_cvt_pk_bf16_f32 v154, v220, v221
  v_cvt_pk_bf16_f32 v155, v222, v223
  ds_write_b128 v250, v[152:155] offset:5120
  buffer_store_dwordx4 v[152:155], v250, s[36:39], s53 offen offset:1024 sc1
  s_waitcnt vmcnt(3)
  buffer_store_dword v254, v253, s[36:39], 0 offen sc1
  v_lshlrev_b32 v216, 16, v156
  v_and_b32 v217, 0xffff0000, v156
  v_lshlrev_b32 v218, 16, v157
  v_and_b32 v219, 0xffff0000, v157
  v_lshlrev_b32 v220, 16, v158
  v_and_b32 v221, 0xffff0000, v158
  v_lshlrev_b32 v222, 16, v159
  v_and_b32 v223, 0xffff0000, v159
  v_pk_fma_f32 v[216:217], v[120:121], v[56:57], v[216:217]
  v_pk_fma_f32 v[218:219], v[122:123], v[58:59], v[218:219]
  v_pk_fma_f32 v[220:221], v[124:125], v[60:61], v[220:221]
  v_pk_fma_f32 v[222:223], v[126:127], v[62:63], v[222:223]
  v_cvt_pk_bf16_f32 v156, v216, v217
  v_cvt_pk_bf16_f32 v157, v218, v219
  v_cvt_pk_bf16_f32 v158, v220, v221
  v_cvt_pk_bf16_f32 v159, v222, v223
  ds_write_b128 v250, v[156:159] offset:7168
  buffer_store_dwordx4 v[156:159], v250, s[36:39], s53 offen offset:3072 sc1
  s_branch L_layer

L_xload:
  s_sub_u32 s40, s40, 4

  v_lshlrev_b32 v2, 4, v0
  v_and_b32 v3, 31, v0
  v_lshlrev_b32 v3, 2, v3
  s_lshl_b32 s78, s41, 8
  v_add_u32 v3, s78, v3
  v_and_b32 v12, 15, v0
  v_lshlrev_b32 v12, 2, v12
  s_add_u32 s78, s78, 128
  v_add_u32 v12, s78, v12
  s_lshl_b32 s79, s42, 1
  s_add_u32 s79, s79, s40
  s_lshl_b32 s79, s79, 2
  s_add_u32 s78, s78, s79
  v_mov_b32 v13, 0x40000000
  v_mov_b32 v14, s78
  v_cmp_eq_u32 vcc, 0, v0
  s_nop 1
  v_cndmask_b32 v13, v13, v14, vcc
  s_add_u32 s79, s42, 1
  s_and_b32 s79, s79, 7
  v_and_b32 v20, 15, v0
  v_lshrrev_b32 v20, 1, v20
  v_cmp_eq_u32 vcc, s79, v20
  s_nop 1
  v_cndmask_b32 v20, 0, 1, vcc
  v_lshrrev_b32 v4, 3, v0
  v_lshlrev_b32 v4, 11, v4
  v_and_b32 v5, 7, v0
  v_lshrrev_b32 v6, 4, v0
  v_xor_b32 v7, v5, v6
  v_lshl_add_u32 v7, v7, 4, v4
  v_add_u32 v6, 4, v6
  v_xor_b32 v8, v5, v6
  v_lshl_add_u32 v8, v8, 4, v4
  s_mov_b32 s81, 0
  s_mov_b32 s82, 0
  s_lshl_b32 s44, s42, 8
  s_mul_i32 s78, s43, 0
  s_add_u32 s78, s78, 0
  s_cmp_ge_u32 s78, 7
  s_cselect_b32 s79, 7, 0
  s_sub_u32 s78, s78, s79
  s_add_u32 s78, s78, s42
  s_add_u32 s78, s78, 1
  s_and_b32 s78, s78, 7
  s_lshl_b32 s45, s78, 8
  s_mul_i32 s78, s43, 0
  s_add_u32 s78, s78, 1
  s_cmp_ge_u32 s78, 7
  s_cselect_b32 s79, 7, 0
  s_sub_u32 s78, s78, s79
  s_add_u32 s78, s78, s42
  s_add_u32 s78, s78, 1
  s_and_b32 s78, s78, 7
  s_lshl_b32 s46, s78, 8
  s_mul_i32 s78, s43, 0
  s_add_u32 s78, s78, 2
  s_cmp_ge_u32 s78, 7
  s_cselect_b32 s79, 7, 0
  s_sub_u32 s78, s78, s79
  s_add_u32 s78, s78, s42
  s_add_u32 s78, s78, 1
  s_and_b32 s78, s78, 7
  s_lshl_b32 s47, s78, 8
  s_mul_i32 s78, s43, 0
  s_add_u32 s78, s78, 3
  s_cmp_ge_u32 s78, 7
  s_cselect_b32 s79, 7, 0
  s_sub_u32 s78, s78, s79
  s_add_u32 s78, s78, s42
  s_add_u32 s78, s78, 1
  s_and_b32 s78, s78, 7
  s_lshl_b32 s48, s78, 8
  s_mul_i32 s78, s43, 0
  s_add_u32 s78, s78, 4
  s_cmp_ge_u32 s78, 7
  s_cselect_b32 s79, 7, 0
  s_sub_u32 s78, s78, s79
  s_add_u32 s78, s78, s42
  s_add_u32 s78, s78, 1
  s_and_b32 s78, s78, 7
  s_lshl_b32 s49, s78, 8
  s_mul_i32 s78, s43, 0
  s_add_u32 s78, s78, 5
  s_cmp_ge_u32 s78, 7
  s_cselect_b32 s79, 7, 0
  s_sub_u32 s78, s78, s79
  s_add_u32 s78, s78, s42
  s_add_u32 s78, s78, 1
  s_and_b32 s78, s78, 7
  s_lshl_b32 s50, s78, 8
  s_mul_i32 s78, s43, 0
  s_add_u32 s78, s78, 6
  s_cmp_ge_u32 s78, 7
  s_cselect_b32 s79, 7, 0
  s_sub_u32 s78, s78, s79
  s_add_u32 s78, s78, s42
  s_add_u32 s78, s78, 1
  s_and_b32 s78, s78, 7
  s_lshl_b32 s51, s78, 8
  s_lshl_b32 s72, s41, 18
  s_lshl_b32 s78, s40, 17
  s_add_u32 s72, s72, s78
  s_lshl_b32 s73, s40, 13
  s_add_u32 m0, s73, 0
  s_add_u32 s78, s72, s44
  s_add_u32 s78, s78, 0
  buffer_load_dwordx4 v7, s[16:19], s78 offen lds
  s_add_u32 m0, s73, 1024
  s_add_u32 s78, s72, s44
  s_add_u32 s78, s78, 16384
  buffer_load_dwordx4 v8, s[16:19], s78 offen lds
  s_add_u32 m0, s73, 2048
  s_add_u32 s78, s72, s44
  s_add_u32 s78, s78, 32768
  buffer_load_dwordx4 v7, s[16:19], s78 offen lds
  s_add_u32 m0, s73, 3072
  s_add_u32 s78, s72, s44
  s_add_u32 s78, s78, 49152
  buffer_load_dwordx4 v8, s[16:19], s78 offen lds
  s_add_u32 m0, s73, 4096
  s_add_u32 s78, s72, s44
  s_add_u32 s78, s78, 65536
  buffer_load_dwordx4 v7, s[16:19], s78 offen lds
  s_add_u32 m0, s73, 5120
  s_add_u32 s78, s72, s44
  s_add_u32 s78, s78, 81920
  buffer_load_dwordx4 v8, s[16:19], s78 offen lds
  s_add_u32 m0, s73, 6144
  s_add_u32 s78, s72, s44
  s_add_u32 s78, s78, 98304
  buffer_load_dwordx4 v7, s[16:19], s78 offen lds
  s_add_u32 m0, s73, 7168
  s_add_u32 s78, s72, s44
  s_add_u32 s78, s78, 114688
  buffer_load_dwordx4 v8, s[16:19], s78 offen lds
  s_barrier
  s_add_u32 m0, s73, 16384
  s_add_u32 s78, s72, s44
  s_add_u32 s78, s78, 128
  buffer_load_dwordx4 v7, s[16:19], s78 offen lds
  s_add_u32 m0, s73, 17408
  s_add_u32 s78, s72, s44
  s_add_u32 s78, s78, 16512
  buffer_load_dwordx4 v8, s[16:19], s78 offen lds
  s_add_u32 m0, s73, 18432
  s_add_u32 s78, s72, s44
  s_add_u32 s78, s78, 32896
  buffer_load_dwordx4 v7, s[16:19], s78 offen lds
  s_add_u32 m0, s73, 19456
  s_add_u32 s78, s72, s44
  s_add_u32 s78, s78, 49280
  buffer_load_dwordx4 v8, s[16:19], s78 offen lds
  s_add_u32 m0, s73, 20480
  s_add_u32 s78, s72, s44
  s_add_u32 s78, s78, 65664
  buffer_load_dwordx4 v7, s[16:19], s78 offen lds
  s_add_u32 m0, s73, 21504
  s_add_u32 s78, s72, s44
  s_add_u32 s78, s78, 82048
  buffer_load_dwordx4 v8, s[16:19], s78 offen lds
  s_add_u32 m0, s73, 22528
  s_add_u32 s78, s72, s44
  s_add_u32 s78, s78, 98432
  buffer_load_dwordx4 v7, s[16:19], s78 offen lds
  s_add_u32 m0, s73, 23552
  s_add_u32 s78, s72, s44
  s_add_u32 s78, s78, 114816
  buffer_load_dwordx4 v8, s[16:19], s78 offen lds
  s_cmp_lg_u32 s40, 0
  s_cbranch_scc1 L_x_nocode
  s_getpc_b64 s[84:85]
L_x_pc:
  s_sub_u32 s84, s84, L_x_pc-standalone__dcn_v2_cross__recsys_kernel
  s_subb_u32 s85, s85, 0
  s_lshr_b32 s78, s2, 3
  s_mul_i32 s78, s78, 704
  s_min_u32 s78, s78, L_end-standalone__dcn_v2_cross__recsys_kernel-704
  s_add_u32 s84, s84, s78
  s_addc_u32 s85, s85, 0
  s_load_dword s86, s[84:85], 0
  s_load_dword s86, s[84:85], 64
  s_load_dword s86, s[84:85], 128
  s_load_dword s86, s[84:85], 192
  s_load_dword s86, s[84:85], 256
  s_load_dword s86, s[84:85], 320
  s_load_dword s86, s[84:85], 384
  s_load_dword s86, s[84:85], 448
  s_load_dword s86, s[84:85], 512
  s_load_dword s86, s[84:85], 576
  s_load_dword s86, s[84:85], 640
L_x_nocode:
  s_waitcnt vmcnt(8)
  s_barrier
  s_add_u32 m0, s73, 32768
  s_add_u32 s78, s72, s45
  s_add_u32 s78, s78, 0
  buffer_load_dwordx4 v7, s[16:19], s78 offen lds
  s_add_u32 m0, s73, 33792
  s_add_u32 s78, s72, s45
  s_add_u32 s78, s78, 16384
  buffer_load_dwordx4 v8, s[16:19], s78 offen lds
  s_add_u32 m0, s73, 34816
  s_add_u32 s78, s72, s45
  s_add_u32 s78, s78, 32768
  buffer_load_dwordx4 v7, s[16:19], s78 offen lds
  s_add_u32 m0, s73, 35840
  s_add_u32 s78, s72, s45
  s_add_u32 s78, s78, 49152
  buffer_load_dwordx4 v8, s[16:19], s78 offen lds
  s_add_u32 m0, s73, 36864
  s_add_u32 s78, s72, s45
  s_add_u32 s78, s78, 65536
  buffer_load_dwordx4 v7, s[16:19], s78 offen lds
  s_add_u32 m0, s73, 37888
  s_add_u32 s78, s72, s45
  s_add_u32 s78, s78, 81920
  buffer_load_dwordx4 v8, s[16:19], s78 offen lds
  s_add_u32 m0, s73, 38912
  s_add_u32 s78, s72, s45
  s_add_u32 s78, s78, 98304
  buffer_load_dwordx4 v7, s[16:19], s78 offen lds
  s_add_u32 m0, s73, 39936
  s_add_u32 s78, s72, s45
  s_add_u32 s78, s78, 114688
  buffer_load_dwordx4 v8, s[16:19], s78 offen lds
  s_waitcnt vmcnt(8)
  s_barrier
  s_add_u32 m0, s73, 49152
  s_add_u32 s78, s72, s45
  s_add_u32 s78, s78, 128
  buffer_load_dwordx4 v7, s[16:19], s78 offen lds
  s_add_u32 m0, s73, 50176
  s_add_u32 s78, s72, s45
  s_add_u32 s78, s78, 16512
  buffer_load_dwordx4 v8, s[16:19], s78 offen lds
  s_add_u32 m0, s73, 51200
  s_add_u32 s78, s72, s45
  s_add_u32 s78, s78, 32896
  buffer_load_dwordx4 v7, s[16:19], s78 offen lds
  s_add_u32 m0, s73, 52224
  s_add_u32 s78, s72, s45
  s_add_u32 s78, s78, 49280
  buffer_load_dwordx4 v8, s[16:19], s78 offen lds
  s_add_u32 m0, s73, 53248
  s_add_u32 s78, s72, s45
  s_add_u32 s78, s78, 65664
  buffer_load_dwordx4 v7, s[16:19], s78 offen lds
  s_add_u32 m0, s73, 54272
  s_add_u32 s78, s72, s45
  s_add_u32 s78, s78, 82048
  buffer_load_dwordx4 v8, s[16:19], s78 offen lds
  s_add_u32 m0, s73, 55296
  s_add_u32 s78, s72, s45
  s_add_u32 s78, s78, 98432
  buffer_load_dwordx4 v7, s[16:19], s78 offen lds
  s_add_u32 m0, s73, 56320
  s_add_u32 s78, s72, s45
  s_add_u32 s78, s78, 114816
  buffer_load_dwordx4 v8, s[16:19], s78 offen lds
  s_barrier
  s_add_u32 m0, s73, 0
  s_add_u32 s78, s72, s46
  s_add_u32 s78, s78, 0
  buffer_load_dwordx4 v7, s[16:19], s78 offen lds
  s_add_u32 m0, s73, 1024
  s_add_u32 s78, s72, s46
  s_add_u32 s78, s78, 16384
  buffer_load_dwordx4 v8, s[16:19], s78 offen lds
  s_add_u32 m0, s73, 2048
  s_add_u32 s78, s72, s46
  s_add_u32 s78, s78, 32768
  buffer_load_dwordx4 v7, s[16:19], s78 offen lds
  s_add_u32 m0, s73, 3072
  s_add_u32 s78, s72, s46
  s_add_u32 s78, s78, 49152
  buffer_load_dwordx4 v8, s[16:19], s78 offen lds
  s_waitcnt vmcnt(12)
  s_barrier
  s_add_u32 m0, s73, 4096
  s_add_u32 s78, s72, s46
  s_add_u32 s78, s78, 65536
  buffer_load_dwordx4 v7, s[16:19], s78 offen lds
  s_add_u32 m0, s73, 5120
  s_add_u32 s78, s72, s46
  s_add_u32 s78, s78, 81920
  buffer_load_dwordx4 v8, s[16:19], s78 offen lds
  s_add_u32 m0, s73, 6144
  s_add_u32 s78, s72, s46
  s_add_u32 s78, s78, 98304
  buffer_load_dwordx4 v7, s[16:19], s78 offen lds
  s_add_u32 m0, s73, 7168
  s_add_u32 s78, s72, s46
  s_add_u32 s78, s78, 114688
  buffer_load_dwordx4 v8, s[16:19], s78 offen lds
  s_barrier
  s_add_u32 m0, s73, 16384
  s_add_u32 s78, s72, s46
  s_add_u32 s78, s78, 128
  buffer_load_dwordx4 v7, s[16:19], s78 offen lds
  s_add_u32 m0, s73, 17408
  s_add_u32 s78, s72, s46
  s_add_u32 s78, s78, 16512
  buffer_load_dwordx4 v8, s[16:19], s78 offen lds
  s_add_u32 m0, s73, 18432
  s_add_u32 s78, s72, s46
  s_add_u32 s78, s78, 32896
  buffer_load_dwordx4 v7, s[16:19], s78 offen lds
  s_add_u32 m0, s73, 19456
  s_add_u32 s78, s72, s46
  s_add_u32 s78, s78, 49280
  buffer_load_dwordx4 v8, s[16:19], s78 offen lds
  s_waitcnt vmcnt(12)
  s_barrier
  s_add_u32 m0, s73, 20480
  s_add_u32 s78, s72, s46
  s_add_u32 s78, s78, 65664
  buffer_load_dwordx4 v7, s[16:19], s78 offen lds
  s_add_u32 m0, s73, 21504
  s_add_u32 s78, s72, s46
  s_add_u32 s78, s78, 82048
  buffer_load_dwordx4 v8, s[16:19], s78 offen lds
  s_add_u32 m0, s73, 22528
  s_add_u32 s78, s72, s46
  s_add_u32 s78, s78, 98432
  buffer_load_dwordx4 v7, s[16:19], s78 offen lds
  s_add_u32 m0, s73, 23552
  s_add_u32 s78, s72, s46
  s_add_u32 s78, s78, 114816
  buffer_load_dwordx4 v8, s[16:19], s78 offen lds
  s_waitcnt vmcnt(8)
  s_barrier
  s_add_u32 m0, s73, 32768
  s_add_u32 s78, s72, s47
  s_add_u32 s78, s78, 0
  buffer_load_dwordx4 v7, s[16:19], s78 offen lds
  s_add_u32 m0, s73, 33792
  s_add_u32 s78, s72, s47
  s_add_u32 s78, s78, 16384
  buffer_load_dwordx4 v8, s[16:19], s78 offen lds
  s_add_u32 m0, s73, 34816
  s_add_u32 s78, s72, s47
  s_add_u32 s78, s78, 32768
  buffer_load_dwordx4 v7, s[16:19], s78 offen lds
  s_add_u32 m0, s73, 35840
  s_add_u32 s78, s72, s47
  s_add_u32 s78, s78, 49152
  buffer_load_dwordx4 v8, s[16:19], s78 offen lds
  s_add_u32 m0, s73, 36864
  s_add_u32 s78, s72, s47
  s_add_u32 s78, s78, 65536
  buffer_load_dwordx4 v7, s[16:19], s78 offen lds
  s_add_u32 m0, s73, 37888
  s_add_u32 s78, s72, s47
  s_add_u32 s78, s78, 81920
  buffer_load_dwordx4 v8, s[16:19], s78 offen lds
  s_add_u32 m0, s73, 38912
  s_add_u32 s78, s72, s47
  s_add_u32 s78, s78, 98304
  buffer_load_dwordx4 v7, s[16:19], s78 offen lds
  s_add_u32 m0, s73, 39936
  s_add_u32 s78, s72, s47
  s_add_u32 s78, s78, 114688
  buffer_load_dwordx4 v8, s[16:19], s78 offen lds
  s_waitcnt vmcnt(8)
  s_barrier
  s_add_u32 m0, s73, 49152
  s_add_u32 s78, s72, s47
  s_add_u32 s78, s78, 128
  buffer_load_dwordx4 v7, s[16:19], s78 offen lds
  s_add_u32 m0, s73, 50176
  s_add_u32 s78, s72, s47
  s_add_u32 s78, s78, 16512
  buffer_load_dwordx4 v8, s[16:19], s78 offen lds
  s_add_u32 m0, s73, 51200
  s_add_u32 s78, s72, s47
  s_add_u32 s78, s78, 32896
  buffer_load_dwordx4 v7, s[16:19], s78 offen lds
  s_add_u32 m0, s73, 52224
  s_add_u32 s78, s72, s47
  s_add_u32 s78, s78, 49280
  buffer_load_dwordx4 v8, s[16:19], s78 offen lds
  s_add_u32 m0, s73, 53248
  s_add_u32 s78, s72, s47
  s_add_u32 s78, s78, 65664
  buffer_load_dwordx4 v7, s[16:19], s78 offen lds
  s_add_u32 m0, s73, 54272
  s_add_u32 s78, s72, s47
  s_add_u32 s78, s78, 82048
  buffer_load_dwordx4 v8, s[16:19], s78 offen lds
  s_add_u32 m0, s73, 55296
  s_add_u32 s78, s72, s47
  s_add_u32 s78, s78, 98432
  buffer_load_dwordx4 v7, s[16:19], s78 offen lds
  s_add_u32 m0, s73, 56320
  s_add_u32 s78, s72, s47
  s_add_u32 s78, s78, 114816
  buffer_load_dwordx4 v8, s[16:19], s78 offen lds
  s_lshl_b32 s76, s41, 18
  s_lshl_b32 s79, s42, 15
  s_add_u32 s76, s76, s79
  s_lshl_b32 s79, s40, 14
  s_add_u32 s76, s76, s79
  s_add_u32 s76, s76, 0x800000
  v_mov_b32 v16, 0
  v_mov_b32 v17, 0
  v_mov_b32 v18, 0
  v_mov_b32 v19, 0
  s_add_u32 s78, s76, 0
  buffer_store_dwordx4 v[16:19], v2, s[36:39], s78 offen
  s_add_u32 s78, s76, 1024
  buffer_store_dwordx4 v[16:19], v2, s[36:39], s78 offen
  s_waitcnt vmcnt(10)
  s_barrier
  s_add_u32 m0, s73, 0
  s_add_u32 s78, s72, s48
  s_add_u32 s78, s78, 0
  buffer_load_dwordx4 v7, s[16:19], s78 offen lds
  s_add_u32 m0, s73, 1024
  s_add_u32 s78, s72, s48
  s_add_u32 s78, s78, 16384
  buffer_load_dwordx4 v8, s[16:19], s78 offen lds
  s_add_u32 m0, s73, 2048
  s_add_u32 s78, s72, s48
  s_add_u32 s78, s78, 32768
  buffer_load_dwordx4 v7, s[16:19], s78 offen lds
  s_add_u32 m0, s73, 3072
  s_add_u32 s78, s72, s48
  s_add_u32 s78, s78, 49152
  buffer_load_dwordx4 v8, s[16:19], s78 offen lds
  s_add_u32 m0, s73, 4096
  s_add_u32 s78, s72, s48
  s_add_u32 s78, s78, 65536
  buffer_load_dwordx4 v7, s[16:19], s78 offen lds
  s_add_u32 m0, s73, 5120
  s_add_u32 s78, s72, s48
  s_add_u32 s78, s78, 81920
  buffer_load_dwordx4 v8, s[16:19], s78 offen lds
  s_add_u32 m0, s73, 6144
  s_add_u32 s78, s72, s48
  s_add_u32 s78, s78, 98304
  buffer_load_dwordx4 v7, s[16:19], s78 offen lds
  s_add_u32 m0, s73, 7168
  s_add_u32 s78, s72, s48
  s_add_u32 s78, s78, 114688
  buffer_load_dwordx4 v8, s[16:19], s78 offen lds
  s_add_u32 s78, s76, 2048
  buffer_store_dwordx4 v[16:19], v2, s[36:39], s78 offen
  s_add_u32 s78, s76, 3072
  buffer_store_dwordx4 v[16:19], v2, s[36:39], s78 offen
  s_waitcnt vmcnt(12)
  s_barrier
  s_add_u32 m0, s73, 16384
  s_add_u32 s78, s72, s48
  s_add_u32 s78, s78, 128
  buffer_load_dwordx4 v7, s[16:19], s78 offen lds
  s_add_u32 m0, s73, 17408
  s_add_u32 s78, s72, s48
  s_add_u32 s78, s78, 16512
  buffer_load_dwordx4 v8, s[16:19], s78 offen lds
  s_add_u32 m0, s73, 18432
  s_add_u32 s78, s72, s48
  s_add_u32 s78, s78, 32896
  buffer_load_dwordx4 v7, s[16:19], s78 offen lds
  s_add_u32 m0, s73, 19456
  s_add_u32 s78, s72, s48
  s_add_u32 s78, s78, 49280
  buffer_load_dwordx4 v8, s[16:19], s78 offen lds
  s_add_u32 m0, s73, 20480
  s_add_u32 s78, s72, s48
  s_add_u32 s78, s78, 65664
  buffer_load_dwordx4 v7, s[16:19], s78 offen lds
  s_add_u32 m0, s73, 21504
  s_add_u32 s78, s72, s48
  s_add_u32 s78, s78, 82048
  buffer_load_dwordx4 v8, s[16:19], s78 offen lds
  s_add_u32 m0, s73, 22528
  s_add_u32 s78, s72, s48
  s_add_u32 s78, s78, 98432
  buffer_load_dwordx4 v7, s[16:19], s78 offen lds
  s_add_u32 m0, s73, 23552
  s_add_u32 s78, s72, s48
  s_add_u32 s78, s78, 114816
  buffer_load_dwordx4 v8, s[16:19], s78 offen lds
  s_add_u32 s78, s76, 4096
  buffer_store_dwordx4 v[16:19], v2, s[36:39], s78 offen
  s_add_u32 s78, s76, 5120
  buffer_store_dwordx4 v[16:19], v2, s[36:39], s78 offen
  s_waitcnt vmcnt(12)
  s_barrier
  s_add_u32 m0, s73, 32768
  s_add_u32 s78, s72, s49
  s_add_u32 s78, s78, 0
  buffer_load_dwordx4 v7, s[16:19], s78 offen lds
  s_add_u32 m0, s73, 33792
  s_add_u32 s78, s72, s49
  s_add_u32 s78, s78, 16384
  buffer_load_dwordx4 v8, s[16:19], s78 offen lds
  s_add_u32 m0, s73, 34816
  s_add_u32 s78, s72, s49
  s_add_u32 s78, s78, 32768
  buffer_load_dwordx4 v7, s[16:19], s78 offen lds
  s_add_u32 m0, s73, 35840
  s_add_u32 s78, s72, s49
  s_add_u32 s78, s78, 49152
  buffer_load_dwordx4 v8, s[16:19], s78 offen lds
  s_add_u32 m0, s73, 36864
  s_add_u32 s78, s72, s49
  s_add_u32 s78, s78, 65536
  buffer_load_dwordx4 v7, s[16:19], s78 offen lds
  s_add_u32 m0, s73, 37888
  s_add_u32 s78, s72, s49
  s_add_u32 s78, s78, 81920
  buffer_load_dwordx4 v8, s[16:19], s78 offen lds
  s_add_u32 m0, s73, 38912
  s_add_u32 s78, s72, s49
  s_add_u32 s78, s78, 98304
  buffer_load_dwordx4 v7, s[16:19], s78 offen lds
  s_add_u32 m0, s73, 39936
  s_add_u32 s78, s72, s49
  s_add_u32 s78, s78, 114688
  buffer_load_dwordx4 v8, s[16:19], s78 offen lds
  s_add_u32 s78, s76, 6144
  buffer_store_dwordx4 v[16:19], v2, s[36:39], s78 offen
  s_add_u32 s78, s76, 7168
  buffer_store_dwordx4 v[16:19], v2, s[36:39], s78 offen
  s_waitcnt vmcnt(12)
  s_barrier
  s_add_u32 m0, s73, 49152
  s_add_u32 s78, s72, s49
  s_add_u32 s78, s78, 128
  buffer_load_dwordx4 v7, s[16:19], s78 offen lds
  s_add_u32 m0, s73, 50176
  s_add_u32 s78, s72, s49
  s_add_u32 s78, s78, 16512
  buffer_load_dwordx4 v8, s[16:19], s78 offen lds
  s_add_u32 m0, s73, 51200
  s_add_u32 s78, s72, s49
  s_add_u32 s78, s78, 32896
  buffer_load_dwordx4 v7, s[16:19], s78 offen lds
  s_add_u32 m0, s73, 52224
  s_add_u32 s78, s72, s49
  s_add_u32 s78, s78, 49280
  buffer_load_dwordx4 v8, s[16:19], s78 offen lds
  s_add_u32 m0, s73, 53248
  s_add_u32 s78, s72, s49
  s_add_u32 s78, s78, 65664
  buffer_load_dwordx4 v7, s[16:19], s78 offen lds
  s_add_u32 m0, s73, 54272
  s_add_u32 s78, s72, s49
  s_add_u32 s78, s78, 82048
  buffer_load_dwordx4 v8, s[16:19], s78 offen lds
  s_add_u32 m0, s73, 55296
  s_add_u32 s78, s72, s49
  s_add_u32 s78, s78, 98432
  buffer_load_dwordx4 v7, s[16:19], s78 offen lds
  s_add_u32 m0, s73, 56320
  s_add_u32 s78, s72, s49
  s_add_u32 s78, s78, 114816
  buffer_load_dwordx4 v8, s[16:19], s78 offen lds
  s_add_u32 s78, s76, 8192
  buffer_store_dwordx4 v[16:19], v2, s[36:39], s78 offen
  s_add_u32 s78, s76, 9216
  buffer_store_dwordx4 v[16:19], v2, s[36:39], s78 offen
  s_waitcnt vmcnt(12)
  s_barrier
  s_add_u32 m0, s73, 0
  s_add_u32 s78, s72, s50
  s_add_u32 s78, s78, 0
  buffer_load_dwordx4 v7, s[16:19], s78 offen lds
  s_add_u32 m0, s73, 1024
  s_add_u32 s78, s72, s50
  s_add_u32 s78, s78, 16384
  buffer_load_dwordx4 v8, s[16:19], s78 offen lds
  s_add_u32 m0, s73, 2048
  s_add_u32 s78, s72, s50
  s_add_u32 s78, s78, 32768
  buffer_load_dwordx4 v7, s[16:19], s78 offen lds
  s_add_u32 m0, s73, 3072
  s_add_u32 s78, s72, s50
  s_add_u32 s78, s78, 49152
  buffer_load_dwordx4 v8, s[16:19], s78 offen lds
  s_add_u32 m0, s73, 4096
  s_add_u32 s78, s72, s50
  s_add_u32 s78, s78, 65536
  buffer_load_dwordx4 v7, s[16:19], s78 offen lds
  s_add_u32 m0, s73, 5120
  s_add_u32 s78, s72, s50
  s_add_u32 s78, s78, 81920
  buffer_load_dwordx4 v8, s[16:19], s78 offen lds
  s_add_u32 m0, s73, 6144
  s_add_u32 s78, s72, s50
  s_add_u32 s78, s78, 98304
  buffer_load_dwordx4 v7, s[16:19], s78 offen lds
  s_add_u32 m0, s73, 7168
  s_add_u32 s78, s72, s50
  s_add_u32 s78, s78, 114688
  buffer_load_dwordx4 v8, s[16:19], s78 offen lds
  s_add_u32 s78, s76, 10240
  buffer_store_dwordx4 v[16:19], v2, s[36:39], s78 offen
  s_add_u32 s78, s76, 11264
  buffer_store_dwordx4 v[16:19], v2, s[36:39], s78 offen
  s_waitcnt vmcnt(12)
  s_barrier
  s_add_u32 m0, s73, 16384
  s_add_u32 s78, s72, s50
  s_add_u32 s78, s78, 128
  buffer_load_dwordx4 v7, s[16:19], s78 offen lds
  s_add_u32 m0, s73, 17408
  s_add_u32 s78, s72, s50
  s_add_u32 s78, s78, 16512
  buffer_load_dwordx4 v8, s[16:19], s78 offen lds
  s_add_u32 m0, s73, 18432
  s_add_u32 s78, s72, s50
  s_add_u32 s78, s78, 32896
  buffer_load_dwordx4 v7, s[16:19], s78 offen lds
  s_add_u32 m0, s73, 19456
  s_add_u32 s78, s72, s50
  s_add_u32 s78, s78, 49280
  buffer_load_dwordx4 v8, s[16:19], s78 offen lds
  s_add_u32 m0, s73, 20480
  s_add_u32 s78, s72, s50
  s_add_u32 s78, s78, 65664
  buffer_load_dwordx4 v7, s[16:19], s78 offen lds
  s_add_u32 m0, s73, 21504
  s_add_u32 s78, s72, s50
  s_add_u32 s78, s78, 82048
  buffer_load_dwordx4 v8, s[16:19], s78 offen lds
  s_add_u32 m0, s73, 22528
  s_add_u32 s78, s72, s50
  s_add_u32 s78, s78, 98432
  buffer_load_dwordx4 v7, s[16:19], s78 offen lds
  s_add_u32 m0, s73, 23552
  s_add_u32 s78, s72, s50
  s_add_u32 s78, s78, 114816
  buffer_load_dwordx4 v8, s[16:19], s78 offen lds
  s_add_u32 s78, s76, 12288
  buffer_store_dwordx4 v[16:19], v2, s[36:39], s78 offen
  s_add_u32 s78, s76, 13312
  buffer_store_dwordx4 v[16:19], v2, s[36:39], s78 offen
  s_waitcnt vmcnt(12)
  s_barrier
  s_add_u32 m0, s73, 32768
  s_add_u32 s78, s72, s51
  s_add_u32 s78, s78, 0
  buffer_load_dwordx4 v7, s[16:19], s78 offen lds
  s_add_u32 m0, s73, 33792
  s_add_u32 s78, s72, s51
  s_add_u32 s78, s78, 16384
  buffer_load_dwordx4 v8, s[16:19], s78 offen lds
  s_add_u32 m0, s73, 34816
  s_add_u32 s78, s72, s51
  s_add_u32 s78, s78, 32768
  buffer_load_dwordx4 v7, s[16:19], s78 offen lds
  s_add_u32 m0, s73, 35840
  s_add_u32 s78, s72, s51
  s_add_u32 s78, s78, 49152
  buffer_load_dwordx4 v8, s[16:19], s78 offen lds
  s_add_u32 m0, s73, 36864
  s_add_u32 s78, s72, s51
  s_add_u32 s78, s78, 65536
  buffer_load_dwordx4 v7, s[16:19], s78 offen lds
  s_add_u32 m0, s73, 37888
  s_add_u32 s78, s72, s51
  s_add_u32 s78, s78, 81920
  buffer_load_dwordx4 v8, s[16:19], s78 offen lds
  s_add_u32 m0, s73, 38912
  s_add_u32 s78, s72, s51
  s_add_u32 s78, s78, 98304
  buffer_load_dwordx4 v7, s[16:19], s78 offen lds
  s_add_u32 m0, s73, 39936
  s_add_u32 s78, s72, s51
  s_add_u32 s78, s78, 114688
  buffer_load_dwordx4 v8, s[16:19], s78 offen lds
  s_add_u32 s78, s76, 14336
  buffer_store_dwordx4 v[16:19], v2, s[36:39], s78 offen
  s_add_u32 s78, s76, 15360
  buffer_store_dwordx4 v[16:19], v2, s[36:39], s78 offen
  s_waitcnt vmcnt(12)
  s_barrier
  s_add_u32 m0, s73, 49152
  s_add_u32 s78, s72, s51
  s_add_u32 s78, s78, 128
  buffer_load_dwordx4 v7, s[16:19], s78 offen lds
  s_add_u32 m0, s73, 50176
  s_add_u32 s78, s72, s51
  s_add_u32 s78, s78, 16512
  buffer_load_dwordx4 v8, s[16:19], s78 offen lds
  s_add_u32 m0, s73, 51200
  s_add_u32 s78, s72, s51
  s_add_u32 s78, s78, 32896
  buffer_load_dwordx4 v7, s[16:19], s78 offen lds
  s_add_u32 m0, s73, 52224
  s_add_u32 s78, s72, s51
  s_add_u32 s78, s78, 49280
  buffer_load_dwordx4 v8, s[16:19], s78 offen lds
  s_add_u32 m0, s73, 53248
  s_add_u32 s78, s72, s51
  s_add_u32 s78, s78, 65664
  buffer_load_dwordx4 v7, s[16:19], s78 offen lds
  s_add_u32 m0, s73, 54272
  s_add_u32 s78, s72, s51
  s_add_u32 s78, s78, 82048
  buffer_load_dwordx4 v8, s[16:19], s78 offen lds
  s_add_u32 m0, s73, 55296
  s_add_u32 s78, s72, s51
  s_add_u32 s78, s78, 98432
  buffer_load_dwordx4 v7, s[16:19], s78 offen lds
  s_add_u32 m0, s73, 56320
  s_add_u32 s78, s72, s51
  s_add_u32 s78, s78, 114816
  buffer_load_dwordx4 v8, s[16:19], s78 offen lds
  s_waitcnt vmcnt(10)
  s_barrier
  s_waitcnt vmcnt(0)
  s_barrier
  s_lshl_b32 s78, s41, 2
  s_add_u32 s78, s78, 128
  v_mov_b32 v15, s78
  buffer_load_dword v10, v15, s[32:35], 0 offen sc1
  s_barrier
  s_barrier
  s_mov_b32 s80, 30000
L_x_verdict:
  s_waitcnt vmcnt(0) lgkmcnt(0)
  v_readfirstlane_b32 s78, v10
  s_nop 3
  s_and_b32 s75, s78, 0x88888888
  s_cmp_eq_u32 s75, 0x88888888
  s_cbranch_scc1 L_x_verdict_done
  s_sleep 2
  buffer_load_dword v10, v15, s[32:35], 0 offen sc1
  s_sub_u32 s80, s80, 1
  s_cmp_lg_u32 s80, 0
  s_cbranch_scc1 L_x_verdict
  s_waitcnt vmcnt(0)
L_x_verdict_done:
  s_and_b32 s80, s78, 15
  s_mul_i32 s80, s80, 0x11111111
  s_cmp_eq_u32 s78, s80
  s_cselect_b32 s83, 1, 0
  s_lshr_b32 s52, s44, 6
  s_lshl_b32 s44, s44, 7
  s_lshr_b32 s53, s45, 6
  s_lshl_b32 s45, s45, 7
  s_lshr_b32 s54, s46, 6
  s_lshl_b32 s46, s46, 7
  s_lshr_b32 s55, s47, 6
  s_lshl_b32 s47, s47, 7
  s_lshr_b32 s56, s48, 6
  s_lshl_b32 s48, s48, 7
  s_lshr_b32 s57, s49, 6
  s_lshl_b32 s49, s49, 7
  s_lshr_b32 s58, s50, 6
  s_lshl_b32 s50, s50, 7
  s_lshr_b32 s59, s51, 6
  s_lshl_b32 s51, s51, 7
  s_add_u32 s78, s43, 0
  s_and_b32 s78, s78, 3
  s_lshr_b32 s79, s78, 1
  s_lshl_b32 s79, s79, 14
  s_and_b32 s78, s78, 1
  s_lshl_b32 s78, s78, 10
  s_add_u32 s60, s78, s79
  s_add_u32 s78, s43, 1
  s_and_b32 s78, s78, 3
  s_lshr_b32 s79, s78, 1
  s_lshl_b32 s79, s79, 14
  s_and_b32 s78, s78, 1
  s_lshl_b32 s78, s78, 10
  s_add_u32 s61, s78, s79
  s_add_u32 s78, s43, 2
  s_and_b32 s78, s78, 3
  s_lshr_b32 s79, s78, 1
  s_lshl_b32 s79, s79, 14
  s_and_b32 s78, s78, 1
  s_lshl_b32 s78, s78, 10
  s_add_u32 s62, s78, s79
  s_add_u32 s78, s43, 3
  s_and_b32 s78, s78, 3
  s_lshr_b32 s79, s78, 1
  s_lshl_b32 s79, s79, 14
  s_and_b32 s78, s78, 1
  s_lshl_b32 s78, s78, 10
  s_add_u32 s63, s78, s79
  s_and_b32 s78, s43, 1
  s_lshl_b32 s78, s78, 1
  s_xor_b32 s78, s78, 0
  s_lshr_b32 s79, s78, 1
  s_lshl_b32 s79, s79, 14
  s_and_b32 s78, s78, 1
  s_lshl_b32 s78, s78, 10
  s_add_u32 s78, s78, s79
  s_add_u32 s64, s78, s45
  s_and_b32 s78, s43, 1
  s_lshl_b32 s78, s78, 1
  s_xor_b32 s78, s78, 2
  s_lshr_b32 s79, s78, 1
  s_lshl_b32 s79, s79, 14
  s_and_b32 s78, s78, 1
  s_lshl_b32 s78, s78, 10
  s_add_u32 s78, s78, s79
  s_add_u32 s65, s78, s45
  s_and_b32 s78, s43, 1
  s_lshl_b32 s78, s78, 1
  s_xor_b32 s78, s78, 0
  s_lshr_b32 s79, s78, 1
  s_lshl_b32 s79, s79, 14
  s_and_b32 s78, s78, 1
  s_lshl_b32 s78, s78, 10
  s_add_u32 s78, s78, s79
  s_add_u32 s66, s78, s46
  s_and_b32 s78, s43, 1
  s_lshl_b32 s78, s78, 1
  s_xor_b32 s78, s78, 2
  s_lshr_b32 s79, s78, 1
  s_lshl_b32 s79, s79, 14
  s_and_b32 s78, s78, 1
  s_lshl_b32 s78, s78, 10
  s_add_u32 s78, s78, s79
  s_add_u32 s67, s78, s46
  s_and_b32 s78, s43, 1
  s_lshl_b32 s78, s78, 1
  s_xor_b32 s78, s78, 1
  s_lshr_b32 s79, s78, 1
  s_lshl_b32 s79, s79, 14
  s_and_b32 s78, s78, 1
  s_lshl_b32 s78, s78, 10
  s_add_u32 s78, s78, s79
  s_add_u32 s68, s78, s45
  s_and_b32 s78, s43, 1
  s_lshl_b32 s78, s78, 1
  s_xor_b32 s78, s78, 3
  s_lshr_b32 s79, s78, 1
  s_lshl_b32 s79, s79, 14
  s_and_b32 s78, s78, 1
  s_lshl_b32 s78, s78, 10
  s_add_u32 s78, s78, s79
  s_add_u32 s69, s78, s45
  s_and_b32 s78, s43, 1
  s_lshl_b32 s78, s78, 1
  s_xor_b32 s78, s78, 1
  s_lshr_b32 s79, s78, 1
  s_lshl_b32 s79, s79, 14
  s_and_b32 s78, s78, 1
  s_lshl_b32 s78, s78, 10
  s_add_u32 s78, s78, s79
  s_add_u32 s70, s78, s46
  s_and_b32 s78, s43, 1
  s_lshl_b32 s78, s78, 1
  s_xor_b32 s78, s78, 3
  s_lshr_b32 s79, s78, 1
  s_lshl_b32 s79, s79, 14
  s_and_b32 s78, s78, 1
  s_lshl_b32 s78, s78, 10
  s_add_u32 s78, s78, s79
  s_add_u32 s71, s78, s46
  s_lshl_b32 s72, s41, 18
  s_add_u32 s72, s72, s73
  s_add_u32 s72, s72, 0x800000
  s_mov_b32 s75, 1
L_x_layer:
  s_mov_b32 s74, 0
  s_lshl_b32 s77, s75, 1
  s_sub_u32 s76, s77, 1
  s_add_u32 s82, s82, 1
  s_add_u32 s78, s72, 0x800000
  s_cmp_eq_u32 s83, 0
  s_cselect_b32 s72, s78, s72
  s_barrier
  s_mov_b32 s80, 30000
L_x_poll0:
  buffer_load_dword v9, v3, s[36:39], 0 offen sc1
  s_waitcnt vmcnt(0)
  v_cmp_le_u32 vcc, s77, v9
  s_nop 3
  s_mov_b32 s74, vcc_lo
  v_cmp_le_u32 vcc, s76, v9
  s_nop 3
  s_mov_b32 s98, vcc_lo
  s_lshr_b32 s78, vcc_lo, s53
  s_and_b32 s78, s78, 15
  s_cmp_eq_u32 s78, 15
  s_cbranch_scc1 L_x_ok0
  s_cmp_lg_u32 s81, 0
  s_cbranch_scc1 L_x_ok0
  s_sub_u32 s80, s80, 1
  s_cmp_lg_u32 s80, 0
  s_cbranch_scc1 L_x_poll0
  s_mov_b32 s81, 1
L_x_ok0:
  s_add_u32 m0, s73, 32768
  s_add_u32 s78, s72, s64
  buffer_load_dwordx4 v2, s[36:39], s78 offen offset:0 sc1 lds
  buffer_load_dwordx4 v2, s[36:39], s78 offen offset:2048 sc1 lds
  s_add_u32 m0, s73, 36864
  s_add_u32 s78, s72, s64
  s_add_u32 s78, s78, 4096
  buffer_load_dwordx4 v2, s[36:39], s78 offen offset:0 sc1 lds
  buffer_load_dwordx4 v2, s[36:39], s78 offen offset:2048 sc1 lds
  s_add_u32 m0, s73, 33792
  s_add_u32 s78, s72, s65
  buffer_load_dwordx4 v2, s[36:39], s78 offen offset:0 sc1 lds
  buffer_load_dwordx4 v2, s[36:39], s78 offen offset:2048 sc1 lds
  s_add_u32 m0, s73, 37888
  s_add_u32 s78, s72, s65
  s_add_u32 s78, s78, 4096
  buffer_load_dwordx4 v2, s[36:39], s78 offen offset:0 sc1 lds
  buffer_load_dwordx4 v2, s[36:39], s78 offen offset:2048 sc1 lds
  s_lshr_b32 s78, s98, s54
  s_and_b32 s78, s78, 15
  s_cmp_eq_u32 s78, 15
  s_cbranch_scc1 L_x_ok1
  s_mov_b32 s80, 30000
L_x_poll1:
  buffer_load_dword v9, v3, s[36:39], 0 offen sc1
  s_waitcnt vmcnt(0)
  v_cmp_le_u32 vcc, s77, v9
  s_nop 3
  s_mov_b32 s74, vcc_lo
  v_cmp_le_u32 vcc, s76, v9
  s_nop 3
  s_mov_b32 s98, vcc_lo
  s_lshr_b32 s78, vcc_lo, s54
  s_and_b32 s78, s78, 15
  s_cmp_eq_u32 s78, 15
  s_cbranch_scc1 L_x_ok1
  s_cmp_lg_u32 s81, 0
  s_cbranch_scc1 L_x_ok1
  s_sub_u32 s80, s80, 1
  s_cmp_lg_u32 s80, 0
  s_cbranch_scc1 L_x_poll1
  s_mov_b32 s81, 1
L_x_ok1:
  s_add_u32 m0, s73, 49152
  s_add_u32 s78, s72, s66
  buffer_load_dwordx4 v2, s[36:39], s78 offen offset:0 sc1 lds
  buffer_load_dwordx4 v2, s[36:39], s78 offen offset:2048 sc1 lds
  s_add_u32 m0, s73, 53248
  s_add_u32 s78, s72, s66
  s_add_u32 s78, s78, 4096
  buffer_load_dwordx4 v2, s[36:39], s78 offen offset:0 sc1 lds
  buffer_load_dwordx4 v2, s[36:39], s78 offen offset:2048 sc1 lds
  s_add_u32 m0, s73, 50176
  s_add_u32 s78, s72, s67
  buffer_load_dwordx4 v2, s[36:39], s78 offen offset:0 sc1 lds
  buffer_load_dwordx4 v2, s[36:39], s78 offen offset:2048 sc1 lds
  s_add_u32 m0, s73, 54272
  s_add_u32 s78, s72, s67
  s_add_u32 s78, s78, 4096
  buffer_load_dwordx4 v2, s[36:39], s78 offen offset:0 sc1 lds
  buffer_load_dwordx4 v2, s[36:39], s78 offen offset:2048 sc1 lds
  buffer_load_dword v22, v3, s[36:39], 0 offen sc1
  s_waitcnt vmcnt(13)
  s_barrier
  s_waitcnt vmcnt(0)
  v_cmp_le_u32 vcc, s77, v22
  s_nop 3
  s_mov_b32 s74, vcc_lo
  s_lshr_b32 s78, s74, s53
  s_and_b32 s78, s78, 15
  s_cmp_eq_u32 s78, 15
  s_cbranch_scc1 L_x_ok2
  s_mov_b32 s80, 30000
L_x_poll2:
  buffer_load_dword v9, v3, s[36:39], 0 offen sc1
  s_waitcnt vmcnt(0)
  v_cmp_le_u32 vcc, s77, v9
  s_nop 3
  s_mov_b32 s74, vcc_lo
  v_cmp_le_u32 vcc, s77, v9
  s_nop 3
  s_mov_b32 s98, vcc_lo
  s_lshr_b32 s78, vcc_lo, s53
  s_and_b32 s78, s78, 15
  s_cmp_eq_u32 s78, 15
  s_cbranch_scc1 L_x_ok2
  s_cmp_lg_u32 s81, 0
  s_cbranch_scc1 L_x_ok2
  s_sub_u32 s80, s80, 1
  s_cmp_lg_u32 s80, 0
  s_cbranch_scc1 L_x_poll2
  s_mov_b32 s81, 1
L_x_ok2:
  s_add_u32 m0, s73, 0
  s_add_u32 s78, s72, s68
  buffer_load_dwordx4 v2, s[36:39], s78 offen offset:0 sc1 lds
  buffer_load_dwordx4 v2, s[36:39], s78 offen offset:2048 sc1 lds
  s_add_u32 m0, s73, 4096
  s_add_u32 s78, s72, s68
  s_add_u32 s78, s78, 4096
  buffer_load_dwordx4 v2, s[36:39], s78 offen offset:0 sc1 lds
  buffer_load_dwordx4 v2, s[36:39], s78 offen offset:2048 sc1 lds
  s_add_u32 m0, s73, 1024
  s_add_u32 s78, s72, s69
  s_barrier
  buffer_load_dwordx4 v2, s[36:39], s78 offen offset:0 sc1 lds
  buffer_load_dwordx4 v2, s[36:39], s78 offen offset:2048 sc1 lds
  s_add_u32 m0, s73, 5120
  s_add_u32 s78, s72, s69
  s_add_u32 s78, s78, 4096
  buffer_load_dwordx4 v2, s[36:39], s78 offen offset:0 sc1 lds
  buffer_load_dwordx4 v2, s[36:39], s78 offen offset:2048 sc1 lds
  buffer_load_dword v23, v3, s[36:39], 0 offen sc1
  s_barrier
  s_lshr_b32 s78, s74, s54
  s_and_b32 s78, s78, 15
  s_cmp_eq_u32 s78, 15
  s_cbranch_scc1 L_x_ok3
  s_mov_b32 s80, 30000
L_x_poll3:
  buffer_load_dword v9, v3, s[36:39], 0 offen sc1
  s_waitcnt vmcnt(0)
  v_cmp_le_u32 vcc, s77, v9
  s_nop 3
  s_mov_b32 s74, vcc_lo
  v_cmp_le_u32 vcc, s77, v9
  s_nop 3
  s_mov_b32 s98, vcc_lo
  s_lshr_b32 s78, vcc_lo, s54
  s_and_b32 s78, s78, 15
  s_cmp_eq_u32 s78, 15
  s_cbranch_scc1 L_x_ok3
  s_cmp_lg_u32 s81, 0
  s_cbranch_scc1 L_x_ok3
  s_sub_u32 s80, s80, 1
  s_cmp_lg_u32 s80, 0
  s_cbranch_scc1 L_x_poll3
  s_mov_b32 s81, 1
L_x_ok3:
  s_add_u32 m0, s73, 16384
  s_add_u32 s78, s72, s70
  buffer_load_dwordx4 v2, s[36:39], s78 offen offset:0 sc1 lds
  buffer_load_dwordx4 v2, s[36:39], s78 offen offset:2048 sc1 lds
  s_add_u32 m0, s73, 20480
  s_add_u32 s78, s72, s70
  s_add_u32 s78, s78, 4096
  buffer_load_dwordx4 v2, s[36:39], s78 offen offset:0 sc1 lds
  buffer_load_dwordx4 v2, s[36:39], s78 offen offset:2048 sc1 lds
  s_add_u32 m0, s73, 17408
  s_add_u32 s78, s72, s71
  buffer_load_dwordx4 v2, s[36:39], s78 offen offset:0 sc1 lds
  buffer_load_dwordx4 v2, s[36:39], s78 offen offset:2048 sc1 lds
  s_add_u32 m0, s73, 21504
  s_add_u32 s78, s72, s71
  s_add_u32 s78, s78, 4096
  buffer_load_dwordx4 v2, s[36:39], s78 offen offset:0 sc1 lds
  buffer_load_dwordx4 v2, s[36:39], s78 offen offset:2048 sc1 lds
  s_waitcnt vmcnt(13)
  s_barrier
  s_waitcnt vmcnt(8)
  v_cmp_le_u32 vcc, s77, v23
  s_nop 3
  s_or_b32 s74, s74, vcc_lo
  s_lshr_b32 s78, s74, s55
  s_and_b32 s78, s78, 15
  s_cmp_eq_u32 s78, 15
  s_cbranch_scc1 L_x_ok4
  s_mov_b32 s80, 30000
L_x_poll4:
  buffer_load_dword v9, v3, s[36:39], 0 offen sc1
  s_waitcnt vmcnt(0)
  v_cmp_le_u32 vcc, s77, v9
  s_nop 3
  s_mov_b32 s74, vcc_lo
  v_cmp_le_u32 vcc, s77, v9
  s_nop 3
  s_mov_b32 s98, vcc_lo
  s_lshr_b32 s78, vcc_lo, s55
  s_and_b32 s78, s78, 15
  s_cmp_eq_u32 s78, 15
  s_cbranch_scc1 L_x_ok4
  s_cmp_lg_u32 s81, 0
  s_cbranch_scc1 L_x_ok4
  s_sub_u32 s80, s80, 1
  s_cmp_lg_u32 s80, 0
  s_cbranch_scc1 L_x_poll4
  s_mov_b32 s81, 1
L_x_ok4:
  s_add_u32 m0, s73, 32768
  s_add_u32 s78, s72, s47
  s_add_u32 s78, s78, s60
  buffer_load_dwordx4 v2, s[36:39], s78 offen offset:0 sc1 lds
  buffer_load_dwordx4 v2, s[36:39], s78 offen offset:2048 sc1 lds
  s_add_u32 m0, s73, 36864
  s_add_u32 s78, s72, s47
  s_add_u32 s78, s78, s60
  s_add_u32 s78, s78, 4096
  buffer_load_dwordx4 v2, s[36:39], s78 offen offset:0 sc1 lds
  buffer_load_dwordx4 v2, s[36:39], s78 offen offset:2048 sc1 lds
  s_add_u32 m0, s73, 33792
  s_add_u32 s78, s72, s47
  s_add_u32 s78, s78, s61
  buffer_load_dwordx4 v2, s[36:39], s78 offen offset:0 sc1 lds
  buffer_load_dwordx4 v2, s[36:39], s78 offen offset:2048 sc1 lds
  s_add_u32 m0, s73, 37888
  s_add_u32 s78, s72, s47
  s_add_u32 s78, s78, s61
  s_add_u32 s78, s78, 4096
  buffer_load_dwordx4 v2, s[36:39], s78 offen offset:0 sc1 lds
  buffer_load_dwordx4 v2, s[36:39], s78 offen offset:2048 sc1 lds
  s_waitcnt vmcnt(12)
  s_add_u32 m0, s73, 49152
  s_add_u32 s78, s72, s47
  s_add_u32 s78, s78, s62
  s_barrier
  buffer_load_dwordx4 v2, s[36:39], s78 offen offset:0 sc1 lds
  buffer_load_dwordx4 v2, s[36:39], s78 offen offset:2048 sc1 lds
  s_add_u32 m0, s73, 53248
  s_add_u32 s78, s72, s47
  s_add_u32 s78, s78, s62
  s_add_u32 s78, s78, 4096
  buffer_load_dwordx4 v2, s[36:39], s78 offen offset:0 sc1 lds
  buffer_load_dwordx4 v2, s[36:39], s78 offen offset:2048 sc1 lds
  s_add_u32 m0, s73, 50176
  s_add_u32 s78, s72, s47
  s_add_u32 s78, s78, s63
  buffer_load_dwordx4 v2, s[36:39], s78 offen offset:0 sc1 lds
  buffer_load_dwordx4 v2, s[36:39], s78 offen offset:2048 sc1 lds
  s_add_u32 m0, s73, 54272
  s_add_u32 s78, s72, s47
  s_add_u32 s78, s78, s63
  s_add_u32 s78, s78, 4096
  buffer_load_dwordx4 v2, s[36:39], s78 offen offset:0 sc1 lds
  buffer_load_dwordx4 v2, s[36:39], s78 offen offset:2048 sc1 lds
  s_waitcnt vmcnt(12)
  s_barrier
  s_lshr_b32 s78, s74, s56
  s_and_b32 s78, s78, 15
  s_cmp_eq_u32 s78, 15
  s_cbranch_scc1 L_x_ok5
  s_mov_b32 s80, 30000
L_x_poll5:
  buffer_load_dword v9, v3, s[36:39], 0 offen sc1
  s_waitcnt vmcnt(0)
  v_cmp_le_u32 vcc, s77, v9
  s_nop 3
  s_mov_b32 s74, vcc_lo
  v_cmp_le_u32 vcc, s77, v9
  s_nop 3
  s_mov_b32 s98, vcc_lo
  s_lshr_b32 s78, vcc_lo, s56
  s_and_b32 s78, s78, 15
  s_cmp_eq_u32 s78, 15
  s_cbranch_scc1 L_x_ok5
  s_cmp_lg_u32 s81, 0
  s_cbranch_scc1 L_x_ok5
  s_sub_u32 s80, s80, 1
  s_cmp_lg_u32 s80, 0
  s_cbranch_scc1 L_x_poll5
  s_mov_b32 s81, 1
L_x_ok5:
  s_add_u32 m0, s73, 0
  s_add_u32 s78, s72, s48
  s_add_u32 s78, s78, s60
  buffer_load_dwordx4 v2, s[36:39], s78 offen offset:0 sc1 lds
  buffer_load_dwordx4 v2, s[36:39], s78 offen offset:2048 sc1 lds
  s_add_u32 m0, s73, 4096
  s_add_u32 s78, s72, s48
  s_add_u32 s78, s78, s60
  s_add_u32 s78, s78, 4096
  buffer_load_dwordx4 v2, s[36:39], s78 offen offset:0 sc1 lds
  buffer_load_dwordx4 v2, s[36:39], s78 offen offset:2048 sc1 lds
  s_add_u32 m0, s73, 1024
  s_add_u32 s78, s72, s48
  s_add_u32 s78, s78, s61
  buffer_load_dwordx4 v2, s[36:39], s78 offen offset:0 sc1 lds
  buffer_load_dwordx4 v2, s[36:39], s78 offen offset:2048 sc1 lds
  s_add_u32 m0, s73, 5120
  s_add_u32 s78, s72, s48
  s_add_u32 s78, s78, s61
  s_add_u32 s78, s78, 4096
  buffer_load_dwordx4 v2, s[36:39], s78 offen offset:0 sc1 lds
  buffer_load_dwordx4 v2, s[36:39], s78 offen offset:2048 sc1 lds
  s_waitcnt vmcnt(12)
  s_add_u32 m0, s73, 16384
  s_add_u32 s78, s72, s48
  s_add_u32 s78, s78, s62
  s_barrier
  buffer_load_dwordx4 v2, s[36:39], s78 offen offset:0 sc1 lds
  buffer_load_dwordx4 v2, s[36:39], s78 offen offset:2048 sc1 lds
  s_add_u32 m0, s73, 20480
  s_add_u32 s78, s72, s48
  s_add_u32 s78, s78, s62
  s_add_u32 s78, s78, 4096
  buffer_load_dwordx4 v2, s[36:39], s78 offen offset:0 sc1 lds
  buffer_load_dwordx4 v2, s[36:39], s78 offen offset:2048 sc1 lds
  s_add_u32 m0, s73, 17408
  s_add_u32 s78, s72, s48
  s_add_u32 s78, s78, s63
  buffer_load_dwordx4 v2, s[36:39], s78 offen offset:0 sc1 lds
  buffer_load_dwordx4 v2, s[36:39], s78 offen offset:2048 sc1 lds
  s_add_u32 m0, s73, 21504
  s_add_u32 s78, s72, s48
  s_add_u32 s78, s78, s63
  s_add_u32 s78, s78, 4096
  buffer_load_dwordx4 v2, s[36:39], s78 offen offset:0 sc1 lds
  buffer_load_dwordx4 v2, s[36:39], s78 offen offset:2048 sc1 lds
  s_waitcnt vmcnt(12)
  s_barrier
  s_lshr_b32 s78, s74, s57
  s_and_b32 s78, s78, 15
  s_cmp_eq_u32 s78, 15
  s_cbranch_scc1 L_x_ok6
  s_mov_b32 s80, 30000
L_x_poll6:
  buffer_load_dword v9, v3, s[36:39], 0 offen sc1
  s_waitcnt vmcnt(0)
  v_cmp_le_u32 vcc, s77, v9
  s_nop 3
  s_mov_b32 s74, vcc_lo
  v_cmp_le_u32 vcc, s77, v9
  s_nop 3
  s_mov_b32 s98, vcc_lo
  s_lshr_b32 s78, vcc_lo, s57
  s_and_b32 s78, s78, 15
  s_cmp_eq_u32 s78, 15
  s_cbranch_scc1 L_x_ok6
  s_cmp_lg_u32 s81, 0
  s_cbranch_scc1 L_x_ok6
  s_sub_u32 s80, s80, 1
  s_cmp_lg_u32 s80, 0
  s_cbranch_scc1 L_x_poll6
  s_mov_b32 s81, 1
L_x_ok6:
  s_add_u32 m0, s73, 32768
  s_add_u32 s78, s72, s49
  s_add_u32 s78, s78, s60
  buffer_load_dwordx4 v2, s[36:39], s78 offen offset:0 sc1 lds
  buffer_load_dwordx4 v2, s[36:39], s78 offen offset:2048 sc1 lds
  s_add_u32 m0, s73, 36864
  s_add_u32 s78, s72, s49
  s_add_u32 s78, s78, s60
  s_add_u32 s78, s78, 4096
  buffer_load_dwordx4 v2, s[36:39], s78 offen offset:0 sc1 lds
  buffer_load_dwordx4 v2, s[36:39], s78 offen offset:2048 sc1 lds
  s_add_u32 m0, s73, 33792
  s_add_u32 s78, s72, s49
  s_add_u32 s78, s78, s61
  buffer_load_dwordx4 v2, s[36:39], s78 offen offset:0 sc1 lds
  buffer_load_dwordx4 v2, s[36:39], s78 offen offset:2048 sc1 lds
  s_add_u32 m0, s73, 37888
  s_add_u32 s78, s72, s49
  s_add_u32 s78, s78, s61
  s_add_u32 s78, s78, 4096
  buffer_load_dwordx4 v2, s[36:39], s78 offen offset:0 sc1 lds
  buffer_load_dwordx4 v2, s[36:39], s78 offen offset:2048 sc1 lds
  s_waitcnt vmcnt(12)
  s_add_u32 m0, s73, 49152
  s_add_u32 s78, s72, s49
  s_add_u32 s78, s78, s62
  s_barrier
  buffer_load_dwordx4 v2, s[36:39], s78 offen offset:0 sc1 lds
  buffer_load_dwordx4 v2, s[36:39], s78 offen offset:2048 sc1 lds
  s_add_u32 m0, s73, 53248
  s_add_u32 s78, s72, s49
  s_add_u32 s78, s78, s62
  s_add_u32 s78, s78, 4096
  buffer_load_dwordx4 v2, s[36:39], s78 offen offset:0 sc1 lds
  buffer_load_dwordx4 v2, s[36:39], s78 offen offset:2048 sc1 lds
  s_add_u32 m0, s73, 50176
  s_add_u32 s78, s72, s49
  s_add_u32 s78, s78, s63
  buffer_load_dwordx4 v2, s[36:39], s78 offen offset:0 sc1 lds
  buffer_load_dwordx4 v2, s[36:39], s78 offen offset:2048 sc1 lds
  s_add_u32 m0, s73, 54272
  s_add_u32 s78, s72, s49
  s_add_u32 s78, s78, s63
  s_add_u32 s78, s78, 4096
  buffer_load_dwordx4 v2, s[36:39], s78 offen offset:0 sc1 lds
  buffer_load_dwordx4 v2, s[36:39], s78 offen offset:2048 sc1 lds
  s_waitcnt vmcnt(12)
  s_barrier
  s_lshr_b32 s78, s74, s58
  s_and_b32 s78, s78, 15
  s_cmp_eq_u32 s78, 15
  s_cbranch_scc1 L_x_ok7
  s_mov_b32 s80, 30000
L_x_poll7:
  buffer_load_dword v9, v3, s[36:39], 0 offen sc1
  s_waitcnt vmcnt(0)
  v_cmp_le_u32 vcc, s77, v9
  s_nop 3
  s_mov_b32 s74, vcc_lo
  v_cmp_le_u32 vcc, s77, v9
  s_nop 3
  s_mov_b32 s98, vcc_lo
  s_lshr_b32 s78, vcc_lo, s58
  s_and_b32 s78, s78, 15
  s_cmp_eq_u32 s78, 15
  s_cbranch_scc1 L_x_ok7
  s_cmp_lg_u32 s81, 0
  s_cbranch_scc1 L_x_ok7
  s_sub_u32 s80, s80, 1
  s_cmp_lg_u32 s80, 0
  s_cbranch_scc1 L_x_poll7
  s_mov_b32 s81, 1
L_x_ok7:
  s_add_u32 m0, s73, 0
  s_add_u32 s78, s72, s50
  s_add_u32 s78, s78, s60
  buffer_load_dwordx4 v2, s[36:39], s78 offen offset:0 sc1 lds
  buffer_load_dwordx4 v2, s[36:39], s78 offen offset:2048 sc1 lds
  s_add_u32 m0, s73, 4096
  s_add_u32 s78, s72, s50
  s_add_u32 s78, s78, s60
  s_add_u32 s78, s78, 4096
  buffer_load_dwordx4 v2, s[36:39], s78 offen offset:0 sc1 lds
  buffer_load_dwordx4 v2, s[36:39], s78 offen offset:2048 sc1 lds
  s_add_u32 m0, s73, 1024
  s_add_u32 s78, s72, s50
  s_add_u32 s78, s78, s61
  buffer_load_dwordx4 v2, s[36:39], s78 offen offset:0 sc1 lds
  buffer_load_dwordx4 v2, s[36:39], s78 offen offset:2048 sc1 lds
  s_add_u32 m0, s73, 5120
  s_add_u32 s78, s72, s50
  s_add_u32 s78, s78, s61
  s_add_u32 s78, s78, 4096
  buffer_load_dwordx4 v2, s[36:39], s78 offen offset:0 sc1 lds
  buffer_load_dwordx4 v2, s[36:39], s78 offen offset:2048 sc1 lds
  s_waitcnt vmcnt(12)
  s_add_u32 m0, s73, 16384
  s_add_u32 s78, s72, s50
  s_add_u32 s78, s78, s62
  s_barrier
  buffer_load_dwordx4 v2, s[36:39], s78 offen offset:0 sc1 lds
  buffer_load_dwordx4 v2, s[36:39], s78 offen offset:2048 sc1 lds
  s_add_u32 m0, s73, 20480
  s_add_u32 s78, s72, s50
  s_add_u32 s78, s78, s62
  s_add_u32 s78, s78, 4096
  buffer_load_dwordx4 v2, s[36:39], s78 offen offset:0 sc1 lds
  buffer_load_dwordx4 v2, s[36:39], s78 offen offset:2048 sc1 lds
  s_add_u32 m0, s73, 17408
  s_add_u32 s78, s72, s50
  s_add_u32 s78, s78, s63
  buffer_load_dwordx4 v2, s[36:39], s78 offen offset:0 sc1 lds
  buffer_load_dwordx4 v2, s[36:39], s78 offen offset:2048 sc1 lds
  s_add_u32 m0, s73, 21504
  s_add_u32 s78, s72, s50
  s_add_u32 s78, s78, s63
  s_add_u32 s78, s78, 4096
  buffer_load_dwordx4 v2, s[36:39], s78 offen offset:0 sc1 lds
  buffer_load_dwordx4 v2, s[36:39], s78 offen offset:2048 sc1 lds
  s_waitcnt vmcnt(12)
  s_barrier
  s_lshr_b32 s78, s74, s59
  s_and_b32 s78, s78, 15
  s_cmp_eq_u32 s78, 15
  s_cbranch_scc1 L_x_ok8
  s_mov_b32 s80, 30000
L_x_poll8:
  buffer_load_dword v9, v3, s[36:39], 0 offen sc1
  s_waitcnt vmcnt(0)
  v_cmp_le_u32 vcc, s77, v9
  s_nop 3
  s_mov_b32 s74, vcc_lo
  v_cmp_le_u32 vcc, s77, v9
  s_nop 3
  s_mov_b32 s98, vcc_lo
  s_lshr_b32 s78, vcc_lo, s59
  s_and_b32 s78, s78, 15
  s_cmp_eq_u32 s78, 15
  s_cbranch_scc1 L_x_ok8
  s_cmp_lg_u32 s81, 0
  s_cbranch_scc1 L_x_ok8
  s_sub_u32 s80, s80, 1
  s_cmp_lg_u32 s80, 0
  s_cbranch_scc1 L_x_poll8
  s_mov_b32 s81, 1
L_x_ok8:
  s_add_u32 m0, s73, 32768
  s_add_u32 s78, s72, s51
  s_add_u32 s78, s78, s60
  buffer_load_dwordx4 v2, s[36:39], s78 offen offset:0 sc1 lds
  buffer_load_dwordx4 v2, s[36:39], s78 offen offset:2048 sc1 lds
  s_add_u32 m0, s73, 36864
  s_add_u32 s78, s72, s51
  s_add_u32 s78, s78, s60
  s_add_u32 s78, s78, 4096
  buffer_load_dwordx4 v2, s[36:39], s78 offen offset:0 sc1 lds
  buffer_load_dwordx4 v2, s[36:39], s78 offen offset:2048 sc1 lds
  s_add_u32 m0, s73, 33792
  s_add_u32 s78, s72, s51
  s_add_u32 s78, s78, s61
  buffer_load_dwordx4 v2, s[36:39], s78 offen offset:0 sc1 lds
  buffer_load_dwordx4 v2, s[36:39], s78 offen offset:2048 sc1 lds
  s_add_u32 m0, s73, 37888
  s_add_u32 s78, s72, s51
  s_add_u32 s78, s78, s61
  s_add_u32 s78, s78, 4096
  buffer_load_dwordx4 v2, s[36:39], s78 offen offset:0 sc1 lds
  buffer_load_dwordx4 v2, s[36:39], s78 offen offset:2048 sc1 lds
  s_waitcnt vmcnt(12)
  s_add_u32 m0, s73, 49152
  s_add_u32 s78, s72, s51
  s_add_u32 s78, s78, s62
  s_barrier
  buffer_load_dwordx4 v2, s[36:39], s78 offen offset:0 sc1 lds
  buffer_load_dwordx4 v2, s[36:39], s78 offen offset:2048 sc1 lds
  s_add_u32 m0, s73, 53248
  s_add_u32 s78, s72, s51
  s_add_u32 s78, s78, s62
  s_add_u32 s78, s78, 4096
  buffer_load_dwordx4 v2, s[36:39], s78 offen offset:0 sc1 lds
  buffer_load_dwordx4 v2, s[36:39], s78 offen offset:2048 sc1 lds
  s_add_u32 m0, s73, 50176
  s_add_u32 s78, s72, s51
  s_add_u32 s78, s78, s63
  buffer_load_dwordx4 v2, s[36:39], s78 offen offset:0 sc1 lds
  buffer_load_dwordx4 v2, s[36:39], s78 offen offset:2048 sc1 lds
  s_add_u32 m0, s73, 54272
  s_add_u32 s78, s72, s51
  s_add_u32 s78, s78, s63
  s_add_u32 s78, s78, 4096
  buffer_load_dwordx4 v2, s[36:39], s78 offen offset:0 sc1 lds
  buffer_load_dwordx4 v2, s[36:39], s78 offen offset:2048 sc1 lds
  s_waitcnt vmcnt(12)
  s_cmp_eq_u32 s83, 0
  s_cbranch_scc1 L_x_nomid
  v_mov_b32 v14, s76
  buffer_store_dword v14, v13, s[36:39], 0 offen
L_x_nomid:
  s_barrier
  s_waitcnt vmcnt(0)
  s_cmp_eq_u32 s83, 0
  s_cbranch_scc1 L_x_nodone
  v_mov_b32 v14, s77
  buffer_store_dword v14, v13, s[36:39], 0 offen
L_x_nodone:
  s_barrier
  buffer_load_dword v9, v12, s[36:39], 0 offen sc1
  s_barrier
  v_add_u32 v21, s76, v20

  s_cmp_eq_u32 s83, 0
  s_cbranch_scc1 L_x_dok
  s_mov_b32 s80, 30000
L_x_dtest:
  s_waitcnt vmcnt(0)
  v_cmp_le_u32 vcc, v21, v9
  s_nop 3
  s_and_b32 s78, vcc_lo, 0xffff
  s_cmp_eq_u32 s78, 0xffff
  s_cbranch_scc1 L_x_dok
  s_cmp_lg_u32 s81, 0
  s_cbranch_scc1 L_x_dok
  buffer_load_dword v9, v12, s[36:39], 0 offen sc1
  s_sub_u32 s80, s80, 1
  s_cmp_lg_u32 s80, 0
  s_cbranch_scc1 L_x_dtest
  s_mov_b32 s81, 1
L_x_dok:
  s_barrier
  s_add_u32 s75, s75, 1
  s_cmp_lg_u32 s75, 6
  s_cbranch_scc1 L_x_layer
  s_waitcnt vmcnt(0)
  s_endpgm

L_wload:
  s_sub_u32 s40, s40, 6

  v_lshrrev_b32 v3, 4, v0
  v_and_b32 v4, 15, v0
  v_lshlrev_b32 v5, 1, v3
  v_xor_b32 v6, v4, v5
  v_lshlrev_b32 v6, 4, v6
  v_lshl_add_u32 v6, v3, 11, v6
  v_add_u32 v5, 8, v5
  v_xor_b32 v9, v4, v5
  v_lshlrev_b32 v9, 4, v9
  v_lshl_add_u32 v9, v3, 11, v9
  v_mov_b32 v7, v6
  v_mov_b32 v8, v9
  s_lshl_b32 s44, s42, 18
  s_mul_i32 s66, s43, 0
  s_add_u32 s66, s66, 0
  s_cmp_ge_u32 s66, 7
  s_cselect_b32 s67, 7, 0
  s_sub_u32 s66, s66, s67
  s_add_u32 s66, s66, s42
  s_add_u32 s66, s66, 1
  s_and_b32 s66, s66, 7
  s_lshl_b32 s45, s66, 18
  s_mul_i32 s66, s43, 0
  s_add_u32 s66, s66, 1
  s_cmp_ge_u32 s66, 7
  s_cselect_b32 s67, 7, 0
  s_sub_u32 s66, s66, s67
  s_add_u32 s66, s66, s42
  s_add_u32 s66, s66, 1
  s_and_b32 s66, s66, 7
  s_lshl_b32 s46, s66, 18
  s_mul_i32 s66, s43, 0
  s_add_u32 s66, s66, 2
  s_cmp_ge_u32 s66, 7
  s_cselect_b32 s67, 7, 0
  s_sub_u32 s66, s66, s67
  s_add_u32 s66, s66, s42
  s_add_u32 s66, s66, 1
  s_and_b32 s66, s66, 7
  s_lshl_b32 s47, s66, 18
  s_mul_i32 s66, s43, 0
  s_add_u32 s66, s66, 3
  s_cmp_ge_u32 s66, 7
  s_cselect_b32 s67, 7, 0
  s_sub_u32 s66, s66, s67
  s_add_u32 s66, s66, s42
  s_add_u32 s66, s66, 1
  s_and_b32 s66, s66, 7
  s_lshl_b32 s48, s66, 18
  s_mul_i32 s66, s43, 0
  s_add_u32 s66, s66, 4
  s_cmp_ge_u32 s66, 7
  s_cselect_b32 s67, 7, 0
  s_sub_u32 s66, s66, s67
  s_add_u32 s66, s66, s42
  s_add_u32 s66, s66, 1
  s_and_b32 s66, s66, 7
  s_lshl_b32 s49, s66, 18
  s_mul_i32 s66, s43, 0
  s_add_u32 s66, s66, 5
  s_cmp_ge_u32 s66, 7
  s_cselect_b32 s67, 7, 0
  s_sub_u32 s66, s66, s67
  s_add_u32 s66, s66, s42
  s_add_u32 s66, s66, 1
  s_and_b32 s66, s66, 7
  s_lshl_b32 s50, s66, 18
  s_mul_i32 s66, s43, 0
  s_add_u32 s66, s66, 6
  s_cmp_ge_u32 s66, 7
  s_cselect_b32 s67, 7, 0
  s_sub_u32 s66, s66, s67
  s_add_u32 s66, s66, s42
  s_add_u32 s66, s66, 1
  s_and_b32 s66, s66, 7
  s_lshl_b32 s51, s66, 18
  s_mov_b32 s52, 0
  s_mov_b32 s53, 65536
  s_mov_b32 s54, 131072
  s_mov_b32 s55, 196608
  s_add_u32 s56, s45, 0
  s_add_u32 s57, s45, 65536
  s_add_u32 s58, s45, 131072
  s_add_u32 s59, s45, 196608
  s_add_u32 s60, s46, 0
  s_add_u32 s61, s46, 65536
  s_add_u32 s62, s46, 131072
  s_add_u32 s63, s46, 196608
  s_lshl_b32 s64, s42, 8
  s_lshl_b32 s66, s40, 15
  s_add_u32 s64, s64, s66
  s_lshl_b32 s70, s40, 12
  s_add_u32 s70, s70, 0x10000
  s_mov_b32 s65, 0
  s_mov_b32 s69, 6
  s_mov_b32 s71, 0
  s_add_u32 m0, s70, s65
  s_add_u32 s66, s64, s44
  s_add_u32 s67, s66, 0
  buffer_load_dwordx4 v6, s[20:23], s67 offen offset:0 lds
  s_add_u32 s67, s66, 7168
  buffer_load_dwordx4 v7, s[20:23], s67 offen offset:1024 lds
  s_add_u32 s67, s66, 14336
  buffer_load_dwordx4 v8, s[20:23], s67 offen offset:2048 lds
  s_add_u32 s67, s66, 21504
  buffer_load_dwordx4 v9, s[20:23], s67 offen offset:3072 lds
  s_add_u32 s65, s65, 8192
  s_cmp_eq_u32 s65, 98304
  s_cselect_b32 s65, 0, s65
  s_add_u32 m0, s70, s65
  s_add_u32 s66, s64, s44
  s_add_u32 s67, s66, 65536
  buffer_load_dwordx4 v6, s[20:23], s67 offen offset:0 lds
  s_add_u32 s67, s66, 72704
  buffer_load_dwordx4 v7, s[20:23], s67 offen offset:1024 lds
  s_add_u32 s67, s66, 79872
  buffer_load_dwordx4 v8, s[20:23], s67 offen offset:2048 lds
  s_add_u32 s67, s66, 87040
  buffer_load_dwordx4 v9, s[20:23], s67 offen offset:3072 lds
  s_add_u32 s65, s65, 8192
  s_cmp_eq_u32 s65, 98304
  s_cselect_b32 s65, 0, s65
  s_barrier
  s_add_u32 m0, s70, s65
  s_add_u32 s66, s64, s44
  s_add_u32 s67, s66, 131072
  buffer_load_dwordx4 v6, s[20:23], s67 offen offset:0 lds
  s_add_u32 s67, s66, 138240
  buffer_load_dwordx4 v7, s[20:23], s67 offen offset:1024 lds
  s_add_u32 s67, s66, 145408
  buffer_load_dwordx4 v8, s[20:23], s67 offen offset:2048 lds
  s_add_u32 s67, s66, 152576
  buffer_load_dwordx4 v9, s[20:23], s67 offen offset:3072 lds
  s_add_u32 s65, s65, 8192
  s_cmp_eq_u32 s65, 98304
  s_cselect_b32 s65, 0, s65
  s_add_u32 m0, s70, s65
  s_add_u32 s66, s64, s44
  s_add_u32 s67, s66, 196608
  buffer_load_dwordx4 v6, s[20:23], s67 offen offset:0 lds
  s_add_u32 s67, s66, 203776
  buffer_load_dwordx4 v7, s[20:23], s67 offen offset:1024 lds
  s_add_u32 s67, s66, 210944
  buffer_load_dwordx4 v8, s[20:23], s67 offen offset:2048 lds
  s_add_u32 s67, s66, 218112
  buffer_load_dwordx4 v9, s[20:23], s67 offen offset:3072 lds
  s_add_u32 s65, s65, 8192
  s_cmp_eq_u32 s65, 98304
  s_cselect_b32 s65, 0, s65
  s_lshl_b32 s66, s2, 13
  s_lshl_b32 s67, s40, 12
  s_add_u32 s66, s66, s67
  v_lshlrev_b32 v12, 7, v0
  v_mov_b32 v13, 0x40000000
  v_cmp_gt_u32 vcc, 32, v0
  s_nop 1
  v_cndmask_b32 v12, v13, v12, vcc
  buffer_load_dword v13, v12, s[20:23], s66 offen
  s_and_b32 s66, s2, 31
  s_lshl_b32 s66, s66, 13
  s_lshr_b32 s77, s2, 5
  s_lshl_b32 s67, s77, 8
  s_add_u32 s66, s66, s67
  s_lshl_b32 s67, s40, 7
  s_add_u32 s66, s66, s67
  s_add_u32 s72, s66, 0x200000
  s_add_u32 m0, s70, s65
  s_add_u32 s66, s64, s56
  s_add_u32 s67, s66, 0
  buffer_load_dwordx4 v6, s[20:23], s67 offen offset:0 lds
  s_add_u32 s67, s66, 7168
  buffer_load_dwordx4 v7, s[20:23], s67 offen offset:1024 lds
  s_add_u32 s67, s66, 14336
  buffer_load_dwordx4 v8, s[20:23], s67 offen offset:2048 lds
  s_add_u32 s67, s66, 21504
  buffer_load_dwordx4 v9, s[20:23], s67 offen offset:3072 lds
  s_add_u32 s65, s65, 8192
  s_cmp_eq_u32 s65, 98304
  s_cselect_b32 s65, 0, s65
  s_add_u32 m0, s70, s65
  s_add_u32 s66, s64, s57
  s_add_u32 s67, s66, 0
  buffer_load_dwordx4 v6, s[20:23], s67 offen offset:0 lds
  s_add_u32 s67, s66, 7168
  buffer_load_dwordx4 v7, s[20:23], s67 offen offset:1024 lds
  s_add_u32 s67, s66, 14336
  buffer_load_dwordx4 v8, s[20:23], s67 offen offset:2048 lds
  s_add_u32 s67, s66, 21504
  buffer_load_dwordx4 v9, s[20:23], s67 offen offset:3072 lds
  s_add_u32 s65, s65, 8192
  s_cmp_eq_u32 s65, 98304
  s_cselect_b32 s65, 0, s65
  s_add_u32 m0, s70, s65
  s_add_u32 s66, s64, s58
  s_add_u32 s67, s66, 0
  buffer_load_dwordx4 v6, s[20:23], s67 offen offset:0 lds
  s_add_u32 s67, s66, 7168
  buffer_load_dwordx4 v7, s[20:23], s67 offen offset:1024 lds
  s_add_u32 s67, s66, 14336
  buffer_load_dwordx4 v8, s[20:23], s67 offen offset:2048 lds
  s_add_u32 s67, s66, 21504
  buffer_load_dwordx4 v9, s[20:23], s67 offen offset:3072 lds
  s_add_u32 s65, s65, 8192
  s_cmp_eq_u32 s65, 98304
  s_cselect_b32 s65, 0, s65
  s_add_u32 m0, s70, s65
  s_add_u32 s66, s64, s59
  s_add_u32 s67, s66, 0
  buffer_load_dwordx4 v6, s[20:23], s67 offen offset:0 lds
  s_add_u32 s67, s66, 7168
  buffer_load_dwordx4 v7, s[20:23], s67 offen offset:1024 lds
  s_add_u32 s67, s66, 14336
  buffer_load_dwordx4 v8, s[20:23], s67 offen offset:2048 lds
  s_add_u32 s67, s66, 21504
  buffer_load_dwordx4 v9, s[20:23], s67 offen offset:3072 lds
  s_add_u32 s65, s65, 8192
  s_cmp_eq_u32 s65, 98304
  s_cselect_b32 s65, 0, s65
L_w_layer:
  s_cmp_lg_u32 s71, 0
  s_cbranch_scc1 L_w_b0late
  s_waitcnt vmcnt(25)
  s_branch L_w_b0go
L_w_b0late:
  s_waitcnt vmcnt(16)
L_w_b0go:
  s_barrier
  s_add_u32 s78, s77, 0
  s_and_b32 s78, s78, 7
  s_lshl_b32 s78, s78, 18
  s_add_u32 s78, s78, s72
  s_buffer_load_dword s76, s[20:23], s78 offset:0
  s_buffer_load_dword s76, s[20:23], s78 offset:64
  s_cmp_lg_u32 s71, 0
  s_cbranch_scc1 L_w_skip1
  s_waitcnt vmcnt(21)
  s_barrier
L_w_skip1:
  s_buffer_load_dword s76, s[20:23], s78 offset:2048
  s_buffer_load_dword s76, s[20:23], s78 offset:2112
  s_cmp_lg_u32 s71, 0
  s_cbranch_scc1 L_w_skip2
  s_waitcnt vmcnt(17)
  s_barrier
L_w_skip2:
  s_buffer_load_dword s76, s[20:23], s78 offset:4096
  s_buffer_load_dword s76, s[20:23], s78 offset:4160
  s_waitcnt vmcnt(12)
  s_add_u32 m0, s70, s65
  s_add_u32 s66, s64, s60
  s_add_u32 s67, s66, 0
  s_barrier
  buffer_load_dwordx4 v6, s[20:23], s67 offen offset:0 lds
  s_add_u32 s67, s66, 7168
  buffer_load_dwordx4 v7, s[20:23], s67 offen offset:1024 lds
  s_add_u32 s67, s66, 14336
  buffer_load_dwordx4 v8, s[20:23], s67 offen offset:2048 lds
  s_add_u32 s67, s66, 21504
  buffer_load_dwordx4 v9, s[20:23], s67 offen offset:3072 lds
  s_add_u32 s65, s65, 8192
  s_cmp_eq_u32 s65, 98304
  s_cselect_b32 s65, 0, s65
  s_buffer_load_dword s76, s[20:23], s78 offset:6144
  s_buffer_load_dword s76, s[20:23], s78 offset:6208
  s_waitcnt vmcnt(12)
  s_add_u32 m0, s70, s65
  s_add_u32 s66, s64, s61
  s_add_u32 s67, s66, 0
  s_barrier
  buffer_load_dwordx4 v6, s[20:23], s67 offen offset:0 lds
  s_add_u32 s67, s66, 7168
  buffer_load_dwordx4 v7, s[20:23], s67 offen offset:1024 lds
  s_add_u32 s67, s66, 14336
  buffer_load_dwordx4 v8, s[20:23], s67 offen offset:2048 lds
  s_add_u32 s67, s66, 21504
  buffer_load_dwordx4 v9, s[20:23], s67 offen offset:3072 lds
  s_add_u32 s65, s65, 8192
  s_cmp_eq_u32 s65, 98304
  s_cselect_b32 s65, 0, s65
  s_add_u32 s78, s77, 1
  s_and_b32 s78, s78, 7
  s_lshl_b32 s78, s78, 18
  s_add_u32 s78, s78, s72
  s_buffer_load_dword s76, s[20:23], s78 offset:0
  s_buffer_load_dword s76, s[20:23], s78 offset:64
  s_waitcnt vmcnt(12)
  s_add_u32 m0, s70, s65
  s_add_u32 s66, s64, s62
  s_add_u32 s67, s66, 0
  s_barrier
  buffer_load_dwordx4 v6, s[20:23], s67 offen offset:0 lds
  s_add_u32 s67, s66, 7168
  buffer_load_dwordx4 v7, s[20:23], s67 offen offset:1024 lds
  s_add_u32 s67, s66, 14336
  buffer_load_dwordx4 v8, s[20:23], s67 offen offset:2048 lds
  s_add_u32 s67, s66, 21504
  buffer_load_dwordx4 v9, s[20:23], s67 offen offset:3072 lds
  s_add_u32 s65, s65, 8192
  s_cmp_eq_u32 s65, 98304
  s_cselect_b32 s65, 0, s65
  s_buffer_load_dword s76, s[20:23], s78 offset:2048
  s_buffer_load_dword s76, s[20:23], s78 offset:2112
  s_waitcnt vmcnt(8)
  s_add_u32 m0, s70, s65
  s_add_u32 s66, s64, s63
  s_add_u32 s67, s66, 0
  s_barrier
  buffer_load_dwordx4 v6, s[20:23], s67 offen offset:0 lds
  s_add_u32 s67, s66, 7168
  buffer_load_dwordx4 v7, s[20:23], s67 offen offset:1024 lds
  s_add_u32 s67, s66, 14336
  buffer_load_dwordx4 v8, s[20:23], s67 offen offset:2048 lds
  s_add_u32 s67, s66, 21504
  buffer_load_dwordx4 v9, s[20:23], s67 offen offset:3072 lds
  s_add_u32 s65, s65, 8192
  s_cmp_eq_u32 s65, 98304
  s_cselect_b32 s65, 0, s65
  s_add_u32 m0, s70, s65
  s_add_u32 s66, s64, s47
  s_add_u32 s66, s66, s52
  s_add_u32 s67, s66, 0
  buffer_load_dwordx4 v6, s[20:23], s67 offen offset:0 lds
  s_add_u32 s67, s66, 7168
  buffer_load_dwordx4 v7, s[20:23], s67 offen offset:1024 lds
  s_add_u32 s67, s66, 14336
  buffer_load_dwordx4 v8, s[20:23], s67 offen offset:2048 lds
  s_add_u32 s67, s66, 21504
  buffer_load_dwordx4 v9, s[20:23], s67 offen offset:3072 lds
  s_add_u32 s65, s65, 8192
  s_cmp_eq_u32 s65, 98304
  s_cselect_b32 s65, 0, s65
  s_buffer_load_dword s76, s[20:23], s78 offset:4096
  s_buffer_load_dword s76, s[20:23], s78 offset:4160
  s_buffer_load_dword s76, s[20:23], s78 offset:6144
  s_buffer_load_dword s76, s[20:23], s78 offset:6208
  s_waitcnt vmcnt(8)
  s_add_u32 m0, s70, s65
  s_add_u32 s66, s64, s47
  s_add_u32 s66, s66, s53
  s_add_u32 s67, s66, 0
  s_barrier
  buffer_load_dwordx4 v6, s[20:23], s67 offen offset:0 lds
  s_add_u32 s67, s66, 7168
  buffer_load_dwordx4 v7, s[20:23], s67 offen offset:1024 lds
  s_add_u32 s67, s66, 14336
  buffer_load_dwordx4 v8, s[20:23], s67 offen offset:2048 lds
  s_add_u32 s67, s66, 21504
  buffer_load_dwordx4 v9, s[20:23], s67 offen offset:3072 lds
  s_add_u32 s65, s65, 8192
  s_cmp_eq_u32 s65, 98304
  s_cselect_b32 s65, 0, s65
  s_add_u32 m0, s70, s65
  s_add_u32 s66, s64, s47
  s_add_u32 s66, s66, s54
  s_add_u32 s67, s66, 0
  buffer_load_dwordx4 v6, s[20:23], s67 offen offset:0 lds
  s_add_u32 s67, s66, 7168
  buffer_load_dwordx4 v7, s[20:23], s67 offen offset:1024 lds
  s_add_u32 s67, s66, 14336
  buffer_load_dwordx4 v8, s[20:23], s67 offen offset:2048 lds
  s_add_u32 s67, s66, 21504
  buffer_load_dwordx4 v9, s[20:23], s67 offen offset:3072 lds
  s_add_u32 s65, s65, 8192
  s_cmp_eq_u32 s65, 98304
  s_cselect_b32 s65, 0, s65
  s_add_u32 s78, s77, 2
  s_and_b32 s78, s78, 7
  s_lshl_b32 s78, s78, 18
  s_add_u32 s78, s78, s72
  s_buffer_load_dword s76, s[20:23], s78 offset:0
  s_buffer_load_dword s76, s[20:23], s78 offset:64
  s_buffer_load_dword s76, s[20:23], s78 offset:2048
  s_buffer_load_dword s76, s[20:23], s78 offset:2112
  s_waitcnt vmcnt(8)
  s_add_u32 m0, s70, s65
  s_add_u32 s66, s64, s47
  s_add_u32 s66, s66, s55
  s_add_u32 s67, s66, 0
  s_barrier
  buffer_load_dwordx4 v6, s[20:23], s67 offen offset:0 lds
  s_add_u32 s67, s66, 7168
  buffer_load_dwordx4 v7, s[20:23], s67 offen offset:1024 lds
  s_add_u32 s67, s66, 14336
  buffer_load_dwordx4 v8, s[20:23], s67 offen offset:2048 lds
  s_add_u32 s67, s66, 21504
  buffer_load_dwordx4 v9, s[20:23], s67 offen offset:3072 lds
  s_add_u32 s65, s65, 8192
  s_cmp_eq_u32 s65, 98304
  s_cselect_b32 s65, 0, s65
  s_add_u32 m0, s70, s65
  s_add_u32 s66, s64, s48
  s_add_u32 s66, s66, s52
  s_add_u32 s67, s66, 0
  buffer_load_dwordx4 v6, s[20:23], s67 offen offset:0 lds
  s_add_u32 s67, s66, 7168
  buffer_load_dwordx4 v7, s[20:23], s67 offen offset:1024 lds
  s_add_u32 s67, s66, 14336
  buffer_load_dwordx4 v8, s[20:23], s67 offen offset:2048 lds
  s_add_u32 s67, s66, 21504
  buffer_load_dwordx4 v9, s[20:23], s67 offen offset:3072 lds
  s_add_u32 s65, s65, 8192
  s_cmp_eq_u32 s65, 98304
  s_cselect_b32 s65, 0, s65
  s_buffer_load_dword s76, s[20:23], s78 offset:4096
  s_buffer_load_dword s76, s[20:23], s78 offset:4160
  s_buffer_load_dword s76, s[20:23], s78 offset:6144
  s_buffer_load_dword s76, s[20:23], s78 offset:6208
  s_waitcnt vmcnt(8)
  s_add_u32 m0, s70, s65
  s_add_u32 s66, s64, s48
  s_add_u32 s66, s66, s53
  s_add_u32 s67, s66, 0
  s_barrier
  buffer_load_dwordx4 v6, s[20:23], s67 offen offset:0 lds
  s_add_u32 s67, s66, 7168
  buffer_load_dwordx4 v7, s[20:23], s67 offen offset:1024 lds
  s_add_u32 s67, s66, 14336
  buffer_load_dwordx4 v8, s[20:23], s67 offen offset:2048 lds
  s_add_u32 s67, s66, 21504
  buffer_load_dwordx4 v9, s[20:23], s67 offen offset:3072 lds
  s_add_u32 s65, s65, 8192
  s_cmp_eq_u32 s65, 98304
  s_cselect_b32 s65, 0, s65
  s_add_u32 m0, s70, s65
  s_add_u32 s66, s64, s48
  s_add_u32 s66, s66, s54
  s_add_u32 s67, s66, 0
  buffer_load_dwordx4 v6, s[20:23], s67 offen offset:0 lds
  s_add_u32 s67, s66, 7168
  buffer_load_dwordx4 v7, s[20:23], s67 offen offset:1024 lds
  s_add_u32 s67, s66, 14336
  buffer_load_dwordx4 v8, s[20:23], s67 offen offset:2048 lds
  s_add_u32 s67, s66, 21504
  buffer_load_dwordx4 v9, s[20:23], s67 offen offset:3072 lds
  s_add_u32 s65, s65, 8192
  s_cmp_eq_u32 s65, 98304
  s_cselect_b32 s65, 0, s65
  s_add_u32 s78, s77, 3
  s_and_b32 s78, s78, 7
  s_lshl_b32 s78, s78, 18
  s_add_u32 s78, s78, s72
  s_buffer_load_dword s76, s[20:23], s78 offset:0
  s_buffer_load_dword s76, s[20:23], s78 offset:64
  s_buffer_load_dword s76, s[20:23], s78 offset:2048
  s_buffer_load_dword s76, s[20:23], s78 offset:2112
  s_waitcnt vmcnt(8)
  s_add_u32 m0, s70, s65
  s_add_u32 s66, s64, s48
  s_add_u32 s66, s66, s55
  s_add_u32 s67, s66, 0
  s_barrier
  buffer_load_dwordx4 v6, s[20:23], s67 offen offset:0 lds
  s_add_u32 s67, s66, 7168
  buffer_load_dwordx4 v7, s[20:23], s67 offen offset:1024 lds
  s_add_u32 s67, s66, 14336
  buffer_load_dwordx4 v8, s[20:23], s67 offen offset:2048 lds
  s_add_u32 s67, s66, 21504
  buffer_load_dwordx4 v9, s[20:23], s67 offen offset:3072 lds
  s_add_u32 s65, s65, 8192
  s_cmp_eq_u32 s65, 98304
  s_cselect_b32 s65, 0, s65
  s_add_u32 m0, s70, s65
  s_add_u32 s66, s64, s49
  s_add_u32 s66, s66, s52
  s_add_u32 s67, s66, 0
  buffer_load_dwordx4 v6, s[20:23], s67 offen offset:0 lds
  s_add_u32 s67, s66, 7168
  buffer_load_dwordx4 v7, s[20:23], s67 offen offset:1024 lds
  s_add_u32 s67, s66, 14336
  buffer_load_dwordx4 v8, s[20:23], s67 offen offset:2048 lds
  s_add_u32 s67, s66, 21504
  buffer_load_dwordx4 v9, s[20:23], s67 offen offset:3072 lds
  s_add_u32 s65, s65, 8192
  s_cmp_eq_u32 s65, 98304
  s_cselect_b32 s65, 0, s65
  s_buffer_load_dword s76, s[20:23], s78 offset:4096
  s_buffer_load_dword s76, s[20:23], s78 offset:4160
  s_buffer_load_dword s76, s[20:23], s78 offset:6144
  s_buffer_load_dword s76, s[20:23], s78 offset:6208
  s_waitcnt vmcnt(8)
  s_add_u32 m0, s70, s65
  s_add_u32 s66, s64, s49
  s_add_u32 s66, s66, s53
  s_add_u32 s67, s66, 0
  s_barrier
  buffer_load_dwordx4 v6, s[20:23], s67 offen offset:0 lds
  s_add_u32 s67, s66, 7168
  buffer_load_dwordx4 v7, s[20:23], s67 offen offset:1024 lds
  s_add_u32 s67, s66, 14336
  buffer_load_dwordx4 v8, s[20:23], s67 offen offset:2048 lds
  s_add_u32 s67, s66, 21504
  buffer_load_dwordx4 v9, s[20:23], s67 offen offset:3072 lds
  s_add_u32 s65, s65, 8192
  s_cmp_eq_u32 s65, 98304
  s_cselect_b32 s65, 0, s65
  s_add_u32 m0, s70, s65
  s_add_u32 s66, s64, s49
  s_add_u32 s66, s66, s54
  s_add_u32 s67, s66, 0
  buffer_load_dwordx4 v6, s[20:23], s67 offen offset:0 lds
  s_add_u32 s67, s66, 7168
  buffer_load_dwordx4 v7, s[20:23], s67 offen offset:1024 lds
  s_add_u32 s67, s66, 14336
  buffer_load_dwordx4 v8, s[20:23], s67 offen offset:2048 lds
  s_add_u32 s67, s66, 21504
  buffer_load_dwordx4 v9, s[20:23], s67 offen offset:3072 lds
  s_add_u32 s65, s65, 8192
  s_cmp_eq_u32 s65, 98304
  s_cselect_b32 s65, 0, s65
  s_add_u32 s78, s77, 4
  s_and_b32 s78, s78, 7
  s_lshl_b32 s78, s78, 18
  s_add_u32 s78, s78, s72
  s_buffer_load_dword s76, s[20:23], s78 offset:0
  s_buffer_load_dword s76, s[20:23], s78 offset:64
  s_buffer_load_dword s76, s[20:23], s78 offset:2048
  s_buffer_load_dword s76, s[20:23], s78 offset:2112
  s_waitcnt vmcnt(8)
  s_add_u32 m0, s70, s65
  s_add_u32 s66, s64, s49
  s_add_u32 s66, s66, s55
  s_add_u32 s67, s66, 0
  s_barrier
  buffer_load_dwordx4 v6, s[20:23], s67 offen offset:0 lds
  s_add_u32 s67, s66, 7168
  buffer_load_dwordx4 v7, s[20:23], s67 offen offset:1024 lds
  s_add_u32 s67, s66, 14336
  buffer_load_dwordx4 v8, s[20:23], s67 offen offset:2048 lds
  s_add_u32 s67, s66, 21504
  buffer_load_dwordx4 v9, s[20:23], s67 offen offset:3072 lds
  s_add_u32 s65, s65, 8192
  s_cmp_eq_u32 s65, 98304
  s_cselect_b32 s65, 0, s65
  s_add_u32 m0, s70, s65
  s_add_u32 s66, s64, s50
  s_add_u32 s66, s66, s52
  s_add_u32 s67, s66, 0
  buffer_load_dwordx4 v6, s[20:23], s67 offen offset:0 lds
  s_add_u32 s67, s66, 7168
  buffer_load_dwordx4 v7, s[20:23], s67 offen offset:1024 lds
  s_add_u32 s67, s66, 14336
  buffer_load_dwordx4 v8, s[20:23], s67 offen offset:2048 lds
  s_add_u32 s67, s66, 21504
  buffer_load_dwordx4 v9, s[20:23], s67 offen offset:3072 lds
  s_add_u32 s65, s65, 8192
  s_cmp_eq_u32 s65, 98304
  s_cselect_b32 s65, 0, s65
  s_buffer_load_dword s76, s[20:23], s78 offset:4096
  s_buffer_load_dword s76, s[20:23], s78 offset:4160
  s_buffer_load_dword s76, s[20:23], s78 offset:6144
  s_buffer_load_dword s76, s[20:23], s78 offset:6208
  s_waitcnt vmcnt(8)
  s_add_u32 m0, s70, s65
  s_add_u32 s66, s64, s50
  s_add_u32 s66, s66, s53
  s_add_u32 s67, s66, 0
  s_barrier
  buffer_load_dwordx4 v6, s[20:23], s67 offen offset:0 lds
  s_add_u32 s67, s66, 7168
  buffer_load_dwordx4 v7, s[20:23], s67 offen offset:1024 lds
  s_add_u32 s67, s66, 14336
  buffer_load_dwordx4 v8, s[20:23], s67 offen offset:2048 lds
  s_add_u32 s67, s66, 21504
  buffer_load_dwordx4 v9, s[20:23], s67 offen offset:3072 lds
  s_add_u32 s65, s65, 8192
  s_cmp_eq_u32 s65, 98304
  s_cselect_b32 s65, 0, s65
  s_add_u32 m0, s70, s65
  s_add_u32 s66, s64, s50
  s_add_u32 s66, s66, s54
  s_add_u32 s67, s66, 0
  buffer_load_dwordx4 v6, s[20:23], s67 offen offset:0 lds
  s_add_u32 s67, s66, 7168
  buffer_load_dwordx4 v7, s[20:23], s67 offen offset:1024 lds
  s_add_u32 s67, s66, 14336
  buffer_load_dwordx4 v8, s[20:23], s67 offen offset:2048 lds
  s_add_u32 s67, s66, 21504
  buffer_load_dwordx4 v9, s[20:23], s67 offen offset:3072 lds
  s_add_u32 s65, s65, 8192
  s_cmp_eq_u32 s65, 98304
  s_cselect_b32 s65, 0, s65
  s_add_u32 s78, s77, 5
  s_and_b32 s78, s78, 7
  s_lshl_b32 s78, s78, 18
  s_add_u32 s78, s78, s72
  s_buffer_load_dword s76, s[20:23], s78 offset:0
  s_buffer_load_dword s76, s[20:23], s78 offset:64
  s_buffer_load_dword s76, s[20:23], s78 offset:2048
  s_buffer_load_dword s76, s[20:23], s78 offset:2112
  s_waitcnt vmcnt(8)
  s_add_u32 m0, s70, s65
  s_add_u32 s66, s64, s50
  s_add_u32 s66, s66, s55
  s_add_u32 s67, s66, 0
  s_barrier
  buffer_load_dwordx4 v6, s[20:23], s67 offen offset:0 lds
  s_add_u32 s67, s66, 7168
  buffer_load_dwordx4 v7, s[20:23], s67 offen offset:1024 lds
  s_add_u32 s67, s66, 14336
  buffer_load_dwordx4 v8, s[20:23], s67 offen offset:2048 lds
  s_add_u32 s67, s66, 21504
  buffer_load_dwordx4 v9, s[20:23], s67 offen offset:3072 lds
  s_add_u32 s65, s65, 8192
  s_cmp_eq_u32 s65, 98304
  s_cselect_b32 s65, 0, s65
  s_add_u32 m0, s70, s65
  s_add_u32 s66, s64, s51
  s_add_u32 s66, s66, s52
  s_add_u32 s67, s66, 0
  buffer_load_dwordx4 v6, s[20:23], s67 offen offset:0 lds
  s_add_u32 s67, s66, 7168
  buffer_load_dwordx4 v7, s[20:23], s67 offen offset:1024 lds
  s_add_u32 s67, s66, 14336
  buffer_load_dwordx4 v8, s[20:23], s67 offen offset:2048 lds
  s_add_u32 s67, s66, 21504
  buffer_load_dwordx4 v9, s[20:23], s67 offen offset:3072 lds
  s_add_u32 s65, s65, 8192
  s_cmp_eq_u32 s65, 98304
  s_cselect_b32 s65, 0, s65
  s_buffer_load_dword s76, s[20:23], s78 offset:4096
  s_buffer_load_dword s76, s[20:23], s78 offset:4160
  s_buffer_load_dword s76, s[20:23], s78 offset:6144
  s_buffer_load_dword s76, s[20:23], s78 offset:6208
  s_waitcnt vmcnt(8)
  s_add_u32 m0, s70, s65
  s_add_u32 s66, s64, s51
  s_add_u32 s66, s66, s53
  s_add_u32 s67, s66, 0
  s_barrier
  buffer_load_dwordx4 v6, s[20:23], s67 offen offset:0 lds
  s_add_u32 s67, s66, 7168
  buffer_load_dwordx4 v7, s[20:23], s67 offen offset:1024 lds
  s_add_u32 s67, s66, 14336
  buffer_load_dwordx4 v8, s[20:23], s67 offen offset:2048 lds
  s_add_u32 s67, s66, 21504
  buffer_load_dwordx4 v9, s[20:23], s67 offen offset:3072 lds
  s_add_u32 s65, s65, 8192
  s_cmp_eq_u32 s65, 98304
  s_cselect_b32 s65, 0, s65
  s_add_u32 m0, s70, s65
  s_add_u32 s66, s64, s51
  s_add_u32 s66, s66, s54
  s_add_u32 s67, s66, 0
  buffer_load_dwordx4 v6, s[20:23], s67 offen offset:0 lds
  s_add_u32 s67, s66, 7168
  buffer_load_dwordx4 v7, s[20:23], s67 offen offset:1024 lds
  s_add_u32 s67, s66, 14336
  buffer_load_dwordx4 v8, s[20:23], s67 offen offset:2048 lds
  s_add_u32 s67, s66, 21504
  buffer_load_dwordx4 v9, s[20:23], s67 offen offset:3072 lds
  s_add_u32 s65, s65, 8192
  s_cmp_eq_u32 s65, 98304
  s_cselect_b32 s65, 0, s65
  s_add_u32 s78, s77, 6
  s_and_b32 s78, s78, 7
  s_lshl_b32 s78, s78, 18
  s_add_u32 s78, s78, s72
  s_buffer_load_dword s76, s[20:23], s78 offset:0
  s_buffer_load_dword s76, s[20:23], s78 offset:64
  s_buffer_load_dword s76, s[20:23], s78 offset:2048
  s_buffer_load_dword s76, s[20:23], s78 offset:2112
  s_waitcnt vmcnt(8)
  s_add_u32 m0, s70, s65
  s_add_u32 s66, s64, s51
  s_add_u32 s66, s66, s55
  s_add_u32 s67, s66, 0
  s_barrier
  buffer_load_dwordx4 v6, s[20:23], s67 offen offset:0 lds
  s_add_u32 s67, s66, 7168
  buffer_load_dwordx4 v7, s[20:23], s67 offen offset:1024 lds
  s_add_u32 s67, s66, 14336
  buffer_load_dwordx4 v8, s[20:23], s67 offen offset:2048 lds
  s_add_u32 s67, s66, 21504
  buffer_load_dwordx4 v9, s[20:23], s67 offen offset:3072 lds
  s_add_u32 s65, s65, 8192
  s_cmp_eq_u32 s65, 98304
  s_cselect_b32 s65, 0, s65
  v_mov_b32 v7, v9
  v_mov_b32 v8, v6
  s_add_u32 m0, s70, s65
  s_add_u32 s66, s64, s44
  s_add_u32 s67, s66, 2097152
  buffer_load_dwordx4 v6, s[20:23], s67 offen offset:0 lds
  s_add_u32 s67, s66, 2104320
  buffer_load_dwordx4 v7, s[20:23], s67 offen offset:1024 lds
  s_add_u32 s67, s66, 2111488
  buffer_load_dwordx4 v8, s[20:23], s67 offen offset:2048 lds
  s_add_u32 s67, s66, 2118656
  buffer_load_dwordx4 v9, s[20:23], s67 offen offset:3072 lds
  s_add_u32 s65, s65, 8192
  s_cmp_eq_u32 s65, 98304
  s_cselect_b32 s65, 0, s65
  s_add_u32 m0, s70, s65
  s_add_u32 s66, s64, s44
  s_add_u32 s67, s66, 2162688
  buffer_load_dwordx4 v6, s[20:23], s67 offen offset:0 lds
  s_add_u32 s67, s66, 2169856
  buffer_load_dwordx4 v7, s[20:23], s67 offen offset:1024 lds
  s_add_u32 s67, s66, 2177024
  buffer_load_dwordx4 v8, s[20:23], s67 offen offset:2048 lds
  s_add_u32 s67, s66, 2184192
  buffer_load_dwordx4 v9, s[20:23], s67 offen offset:3072 lds
  s_add_u32 s65, s65, 8192
  s_cmp_eq_u32 s65, 98304
  s_cselect_b32 s65, 0, s65
  s_add_u32 m0, s70, s65
  s_add_u32 s66, s64, s44
  s_add_u32 s67, s66, 2228224
  buffer_load_dwordx4 v6, s[20:23], s67 offen offset:0 lds
  s_add_u32 s67, s66, 2235392
  buffer_load_dwordx4 v7, s[20:23], s67 offen offset:1024 lds
  s_add_u32 s67, s66, 2242560
  buffer_load_dwordx4 v8, s[20:23], s67 offen offset:2048 lds
  s_add_u32 s67, s66, 2249728
  buffer_load_dwordx4 v9, s[20:23], s67 offen offset:3072 lds
  s_add_u32 s65, s65, 8192
  s_cmp_eq_u32 s65, 98304
  s_cselect_b32 s65, 0, s65
  s_buffer_load_dword s76, s[20:23], s78 offset:4096
  s_buffer_load_dword s76, s[20:23], s78 offset:4160
  s_buffer_load_dword s76, s[20:23], s78 offset:6144
  s_buffer_load_dword s76, s[20:23], s78 offset:6208
  s_waitcnt vmcnt(16)
  s_add_u32 m0, s70, s65
  s_add_u32 s66, s64, s44
  s_add_u32 s67, s66, 2293760
  s_barrier
  buffer_load_dwordx4 v6, s[20:23], s67 offen offset:0 lds
  s_add_u32 s67, s66, 2300928
  buffer_load_dwordx4 v7, s[20:23], s67 offen offset:1024 lds
  s_add_u32 s67, s66, 2308096
  buffer_load_dwordx4 v8, s[20:23], s67 offen offset:2048 lds
  s_add_u32 s67, s66, 2315264
  buffer_load_dwordx4 v9, s[20:23], s67 offen offset:3072 lds
  s_add_u32 s65, s65, 8192
  s_cmp_eq_u32 s65, 98304
  s_cselect_b32 s65, 0, s65
  s_add_u32 s66, s43, 0
  s_and_b32 s66, s66, 3
  s_lshl_b32 s52, s66, 16
  s_add_u32 s66, s43, 1
  s_and_b32 s66, s66, 3
  s_lshl_b32 s53, s66, 16
  s_add_u32 s66, s43, 2
  s_and_b32 s66, s66, 3
  s_lshl_b32 s54, s66, 16
  s_add_u32 s66, s43, 3
  s_and_b32 s66, s66, 3
  s_lshl_b32 s55, s66, 16
  s_and_b32 s66, s43, 1
  s_lshl_b32 s66, s66, 1
  s_xor_b32 s66, s66, 0
  s_lshl_b32 s66, s66, 16
  s_add_u32 s56, s66, s45
  s_and_b32 s66, s43, 1
  s_lshl_b32 s66, s66, 1
  s_xor_b32 s66, s66, 2
  s_lshl_b32 s66, s66, 16
  s_add_u32 s57, s66, s45
  s_and_b32 s66, s43, 1
  s_lshl_b32 s66, s66, 1
  s_xor_b32 s66, s66, 0
  s_lshl_b32 s66, s66, 16
  s_add_u32 s58, s66, s46
  s_and_b32 s66, s43, 1
  s_lshl_b32 s66, s66, 1
  s_xor_b32 s66, s66, 2
  s_lshl_b32 s66, s66, 16
  s_add_u32 s59, s66, s46
  s_and_b32 s66, s43, 1
  s_lshl_b32 s66, s66, 1
  s_xor_b32 s66, s66, 1
  s_lshl_b32 s66, s66, 16
  s_add_u32 s60, s66, s45
  s_and_b32 s66, s43, 1
  s_lshl_b32 s66, s66, 1
  s_xor_b32 s66, s66, 3
  s_lshl_b32 s66, s66, 16
  s_add_u32 s61, s66, s45
  s_and_b32 s66, s43, 1
  s_lshl_b32 s66, s66, 1
  s_xor_b32 s66, s66, 1
  s_lshl_b32 s66, s66, 16
  s_add_u32 s62, s66, s46
  s_and_b32 s66, s43, 1
  s_lshl_b32 s66, s66, 1
  s_xor_b32 s66, s66, 3
  s_lshl_b32 s66, s66, 16
  s_add_u32 s63, s66, s46
  s_add_u32 m0, s70, s65
  s_add_u32 s66, s64, s56
  s_add_u32 s67, s66, 2097152
  buffer_load_dwordx4 v6, s[20:23], s67 offen offset:0 lds
  s_add_u32 s67, s66, 2104320
  buffer_load_dwordx4 v7, s[20:23], s67 offen offset:1024 lds
  s_add_u32 s67, s66, 2111488
  buffer_load_dwordx4 v8, s[20:23], s67 offen offset:2048 lds
  s_add_u32 s67, s66, 2118656
  buffer_load_dwordx4 v9, s[20:23], s67 offen offset:3072 lds
  s_add_u32 s65, s65, 8192
  s_cmp_eq_u32 s65, 98304
  s_cselect_b32 s65, 0, s65
  s_add_u32 m0, s70, s65
  s_add_u32 s66, s64, s57
  s_add_u32 s67, s66, 2097152
  buffer_load_dwordx4 v6, s[20:23], s67 offen offset:0 lds
  s_add_u32 s67, s66, 2104320
  buffer_load_dwordx4 v7, s[20:23], s67 offen offset:1024 lds
  s_add_u32 s67, s66, 2111488
  buffer_load_dwordx4 v8, s[20:23], s67 offen offset:2048 lds
  s_add_u32 s67, s66, 2118656
  buffer_load_dwordx4 v9, s[20:23], s67 offen offset:3072 lds
  s_add_u32 s65, s65, 8192
  s_cmp_eq_u32 s65, 98304
  s_cselect_b32 s65, 0, s65
  s_add_u32 s78, s77, 7
  s_and_b32 s78, s78, 7
  s_lshl_b32 s78, s78, 18
  s_add_u32 s78, s78, s72
  s_buffer_load_dword s76, s[20:23], s78 offset:0
  s_buffer_load_dword s76, s[20:23], s78 offset:64
  s_buffer_load_dword s76, s[20:23], s78 offset:2048
  s_buffer_load_dword s76, s[20:23], s78 offset:2112
  s_waitcnt vmcnt(24)
  s_add_u32 m0, s70, s65
  s_add_u32 s66, s64, s58
  s_add_u32 s67, s66, 2097152
  s_barrier
  buffer_load_dwordx4 v6, s[20:23], s67 offen offset:0 lds
  s_add_u32 s67, s66, 2104320
  buffer_load_dwordx4 v7, s[20:23], s67 offen offset:1024 lds
  s_add_u32 s67, s66, 2111488
  buffer_load_dwordx4 v8, s[20:23], s67 offen offset:2048 lds
  s_add_u32 s67, s66, 2118656
  buffer_load_dwordx4 v9, s[20:23], s67 offen offset:3072 lds
  s_add_u32 s65, s65, 8192
  s_cmp_eq_u32 s65, 98304
  s_cselect_b32 s65, 0, s65
  s_add_u32 m0, s70, s65
  s_add_u32 s66, s64, s59
  s_add_u32 s67, s66, 2097152
  buffer_load_dwordx4 v6, s[20:23], s67 offen offset:0 lds
  s_add_u32 s67, s66, 2104320
  buffer_load_dwordx4 v7, s[20:23], s67 offen offset:1024 lds
  s_add_u32 s67, s66, 2111488
  buffer_load_dwordx4 v8, s[20:23], s67 offen offset:2048 lds
  s_add_u32 s67, s66, 2118656
  buffer_load_dwordx4 v9, s[20:23], s67 offen offset:3072 lds
  s_add_u32 s65, s65, 8192
  s_cmp_eq_u32 s65, 98304
  s_cselect_b32 s65, 0, s65
  s_buffer_load_dword s76, s[20:23], s78 offset:4096
  s_buffer_load_dword s76, s[20:23], s78 offset:4160
  s_barrier
  s_buffer_load_dword s76, s[20:23], s78 offset:6144
  s_buffer_load_dword s76, s[20:23], s78 offset:6208
  s_add_u32 s72, s72, 0x200000
  s_add_u32 s64, s64, 0x200000
  s_add_u32 s71, s71, 1
  s_sub_u32 s69, s69, 1
  s_cmp_lg_u32 s69, 0
  s_cbranch_scc1 L_w_layer
  s_waitcnt vmcnt(0) lgkmcnt(0)
  s_endpgm

L_end:
  s_endpgm
.section .rodata,"a"
.p2align 6
.amdhsa_kernel standalone__dcn_v2_cross__recsys_kernel
  .amdhsa_next_free_vgpr 256
  .amdhsa_next_free_sgpr 100
  .amdhsa_accum_offset 256
  .amdhsa_group_segment_fixed_size 0
  .amdhsa_kernarg_size 48
  .amdhsa_user_sgpr_count 2
  .amdhsa_user_sgpr_kernarg_segment_ptr 1
  .amdhsa_system_sgpr_workgroup_id_x 1
.end_amdhsa_kernel
```
